```python
import torch

def _softmax(x, axis=-1):
    return torch.softmax(x, dim=axis)
def _gelu(x):
    return torch.nn.functional.gelu(x, approximate="tanh")
def _silu(x):
    return torch.nn.functional.silu(x)
def _sigmoid(x):
    return torch.sigmoid(x)
def _layernorm(x, axis=-1, eps=1e-5):
    m = x.mean(dim=axis, keepdim=True)
    v = x.var(dim=axis, keepdim=True, unbiased=False)
    return (x - m) / torch.sqrt(v + eps)
def _scatter_add(tgt, idx, src, axis=0):
    return tgt.clone().index_add_(axis, idx, src)
def _segment_sum(src, seg, n):
    out = torch.zeros((n,) + src.shape[1:], dtype=src.dtype)
    return out.index_add_(0, seg, src)
def _pad(x, pw):
    flat = tuple(v for pair in reversed(pw) for v in pair)
    return torch.nn.functional.pad(x, flat)

kernel_name = 'concat_heads__mha_block__mha_block__prompt'

def setup_inputs():

    _w = (lambda a: (lambda t: t.to(torch.bfloat16) if t.is_floating_point() else t)(torch.as_tensor(a)))
    def _A_setup():
        B, S, D, H = 1, 2048, 640, 32
        return {
            "x": _w((lambda *s: torch.randn(*s, dtype=torch.bfloat16) * 0.2)(B, S, D)),
            "wqkv": _w((lambda *s: torch.randn(*s, dtype=torch.bfloat16) * 0.2)(D, 3 * D)),
            "wo": _w((lambda *s: torch.randn(*s, dtype=torch.bfloat16) * 0.05)(D, D)),
        }
    _A_in = _A_setup()

    def _B_setup():
        B, S, D, H = 1, 2048, 640, 32
        return {
            "x": _w((lambda *s: torch.randn(*s, dtype=torch.bfloat16) * 0.2)(B, S, D)),
            "wqkv": _w((lambda *s: torch.randn(*s, dtype=torch.bfloat16) * 0.2)(D, 3 * D)),
            "wo": _w((lambda *s: torch.randn(*s, dtype=torch.bfloat16) * 0.05)(D, D)),
        }
    _B_in = _B_setup()

    return {
        "A_x": _A_in["x"],
        "A_wqkv": _A_in["wqkv"],
        "A_wo": _A_in["wo"],
        "B_x": _B_in["x"],
        "B_wqkv": _B_in["wqkv"],
        "B_wo": _B_in["wo"],
    }

def reference(A_x, A_wqkv, A_wo, B_x, B_wqkv, B_wo):
    def _A_ref(x, wqkv, wo):
        B, S, D = x.shape
        H = 32
        Dh = D // H
        qkv = (lambda x, *d: x.permute(*d))((x @ wqkv).reshape(B, S, 3, H, Dh), 2, 0, 3, 1, 4)
        q, k, v = qkv[0], qkv[1], qkv[2]
        scores = torch.einsum("bhqd,bhkd->bhqk", q, k) * (Dh ** -0.5)
        p = _softmax(scores, axis=-1)
        o = torch.einsum("bhqk,bhkd->bhqd", p, v)
        return (lambda x, *d: x.permute(*d))(o, 0, 2, 1, 3).reshape(B, S, D) @ wo

    def _B_ref(x, wqkv, wo):
        B, S, D = x.shape
        H = 32
        Dh = D // H
        qkv = (lambda x, *d: x.permute(*d))((x @ wqkv).reshape(B, S, 3, H, Dh), 2, 0, 3, 1, 4)
        q, k, v = qkv[0], qkv[1], qkv[2]
        scores = torch.einsum("bhqd,bhkd->bhqk", q, k) * (Dh ** -0.5)
        p = _softmax(scores, axis=-1)
        o = torch.einsum("bhqk,bhkd->bhqd", p, v)
        return (lambda x, *d: x.permute(*d))(o, 0, 2, 1, 3).reshape(B, S, D) @ wo

    a = _A_ref(A_x, A_wqkv, A_wo)
    b = _B_ref(B_x, B_wqkv, B_wo)
    return torch.concatenate([a, b], axis=-1)
```

```asm
; @launch grid=(256,1,1) block=(512,1,1) lds=163840
.amdgcn_target "amdgcn-amd-amdhsa--gfx950"
.text
.globl concat_heads__mha_block__mha_block__prompt_kernel
.p2align 8
.type concat_heads__mha_block__mha_block__prompt_kernel,@function
concat_heads__mha_block__mha_block__prompt_kernel:
    s_cmp_ge_u32 s2, 256
    s_cbranch_scc1 L_end
    s_bfe_u32 s28, s2, 0x10002
    s_mul_i32 s35, s28, 24
    s_load_dwordx4 s[4:7], s[0:1], s35
    s_load_dwordx4 s[72:75], s[0:1], 56
    s_add_u32 s35, s35, 16
    s_load_dwordx2 s[76:77], s[0:1], s35
    s_load_dwordx2 s[78:79], s[0:1], 48
    v_lshrrev_b32 v8, 6, v0
    v_and_b32 v1, 63, v0
    s_and_b32 s61, s2, 3
    v_readfirstlane_b32 s94, v8
    s_lshr_b32 s29, s2, 5
    s_bfe_u32 s30, s2, 0x20003
    s_mul_i32 s27, s61, 5
    s_lshr_b32 s27, s27, 1
    s_mul_i32 s35, s29, 1
    s_add_u32 s27, s27, s35
    s_mul_i32 s35, s30, 0
    s_add_u32 s27, s27, s35
    s_mul_i32 s35, s27, 26
    s_lshr_b32 s35, s35, 8
    s_mul_i32 s35, s35, 10
    s_sub_u32 s27, s27, s35
    s_mul_i32 s25, s29, 327680
    s_mul_i32 s26, s61, 320
    s_mov_b32 s10, 2621440
    s_mov_b32 s11, 0x20000
    s_mov_b32 s14, 2457600
    s_mov_b32 s15, 0x20000
    v_lshrrev_b32 v8, 3, v1
    s_lshl_b32 s35, s94, 5
    v_add_u32 v8, s35, v8
    v_mul_u32_u24 v8, 1280, v8
    v_lshrrev_b32 v9, 4, v1
    v_and_b32 v10, 7, v1
    v_xor_b32 v10, v10, v9
    v_lshl_add_u32 v16, v10, 4, v8
    v_xor_b32 v10, 4, v10
    v_lshl_add_u32 v17, v10, 4, v8
    v_add_u32 v18, 20480, v17
    v_add_u32 v17, 10240, v17
    v_add_u32 v19, 30720, v16
    s_lshl_b32 s64, s30, 2
    s_mul_i32 s66, s30, 1216
    s_sub_u32 s65, s66, 960
    s_cmp_eq_u32 s30, 3
    s_cselect_b32 s66, 0x7f000000, s66
    s_cmp_eq_u32 s30, 0
    s_cselect_b32 s65, 0, s65
    s_lshl_b32 s35, s94, 3
    v_add_u32 v8, s35, v9
    v_mul_u32_u24 v8, 3840, v8
    v_and_b32 v10, 15, v1
    s_and_b32 s35, s94, 1
    s_lshl_b32 s35, s35, 3
    v_lshl_add_u32 v9, v9, 1, s35
    v_xor_b32 v10, v10, v9
    v_mov_b32 v11, s65
    v_mov_b32 v12, s66
    v_cmp_gt_u32 vcc, s64, v10
    v_lshl_add_u32 v20, v10, 4, v8
    s_lshl_b32 s22, s94, 12
    v_cndmask_b32 v11, v12, v11, vcc
    s_lshl_b32 s23, s94, 11
    s_add_u32 s23, s23, 32768
    v_add_u32 v20, v20, v11
    v_add_u32 v21, 15360, v20
    s_lshl_b32 s34, s27, 7
    s_add_u32 s34, s34, s25
    s_mul_i32 s35, s27, 245760
    s_add_u32 s35, s35, s26
    s_add_u32 s36, s22, 0
    s_add_u32 s37, s23, 0
    s_add_u32 s27, s27, 1
    s_cmp_eq_u32 s27, 10
    s_cselect_b32 s27, 0, s27
    s_add_u32 m0, s36, 0
    s_waitcnt lgkmcnt(0)
    s_mov_b32 s8, s4
    s_mov_b32 s9, s5
    s_mov_b32 s12, s6
    s_mov_b32 s13, s7
    buffer_load_dwordx4 v16, s[8:11], s34 offen lds
    s_add_u32 m0, s37, 0
    s_nop 0
    buffer_load_dwordx4 v20, s[12:15], s35 offen lds
    s_add_u32 m0, s36, 1024
    s_nop 0
    buffer_load_dwordx4 v17, s[8:11], s34 offen lds
    s_add_u32 m0, s37, 1024
    s_nop 0
    buffer_load_dwordx4 v21, s[12:15], s35 offen lds
    s_add_u32 m0, s36, 2048
    s_nop 0
    buffer_load_dwordx4 v18, s[8:11], s34 offen lds
    s_add_u32 m0, s36, 3072
    s_nop 0
    buffer_load_dwordx4 v19, s[8:11], s34 offen lds
    s_lshl_b32 s31, s30, 1
    s_and_b32 s36, s94, 1
    s_add_u32 s31, s31, s36
    s_lshl_b32 s35, s31, 5
    s_getpc_b64 s[36:37]
L_pc:
    s_add_u32 s36, s36, L_tab-L_pc
    s_addc_u32 s37, s37, 0
    s_load_dwordx8 s[40:47], s[36:37], s35
    s_add_u32 s80, s36, 256
    s_addc_u32 s81, s37, 0
    s_mov_b32 s92, s72
    s_mov_b32 s93, s73
    s_mov_b32 s88, s74
    s_mov_b32 s89, s75
    s_mov_b32 s84, 0
    s_and_b32 s35, s2, 7
    s_lshl_b32 s62, s35, 8
    s_and_b32 s35, s2, 0xf8
    s_add_u32 s62, s62, s35
    s_add_u32 s62, s62, 22609920
    s_cmp_lg_u32 s94, 7
    s_cbranch_scc1 L_ntl
    v_min_u32 v8, 10, v1
    v_mul_u32_u24 v8, 2097152, v8
    v_min_u32 v9, 2, v1
    v_mul_u32_u24 v9, 2097152, v9
    v_min_u32 v9, 5242876, v9
    v_mov_b32 v10, 0
    global_load_dword v163, v8, s[74:75] sc1
    global_load_dword v163, v9, s[78:79] sc1
    global_load_dword v163, v10, s[76:77] sc1
    global_load_dword v163, v10, s[72:73] sc1
L_ntl:
    s_lshl_b32 s34, s2, 3
    s_add_u32 s34, s34, s94
    s_cmp_lg_u32 s34, 7
    s_cbranch_scc1 L_nt
    s_memrealtime s[34:35]
    s_waitcnt lgkmcnt(0)
    s_or_b32 s34, s34, 0x10
    v_mov_b32 v8, 0
    v_mov_b32 v10, s34
    v_mov_b32 v11, s35
    s_mov_b64 exec, 1
    global_store_dwordx2 v8, v[10:11], s[92:93] sc1
    s_mov_b64 exec, -1
L_nt:
    v_and_b32 v8, 15, v1
    v_lshrrev_b32 v9, 1, v8
    v_bfe_u32 v10, v8, 2, 1
    v_lshrrev_b32 v11, 3, v8
    v_and_b32 v12, 3, v8
    v_lshl_add_u32 v12, v11, 2, v12
    v_lshl_add_u32 v12, v10, 4, v12
    v_and_b32 v13, 1, v9
    v_lshl_add_u32 v13, v11, 1, v13
    v_lshl_add_u32 v13, v10, 2, v13
    s_cmp_ge_u32 s31, 5
    s_cselect_b64 vcc, -1, 0
    s_lshr_b32 s35, s94, 1
    s_lshl_b32 s35, s35, 13
    v_cndmask_b32 v12, v12, v8, vcc
    v_cndmask_b32 v13, v13, v9, vcc
    v_lshrrev_b32 v10, 4, v1
    v_xor_b32 v13, v13, v10
    v_lshlrev_b32 v12, 7, v12
    v_lshl_add_u32 v12, v13, 4, v12
    v_add_u32 v2, s35, v12
    v_xor_b32 v3, 64, v2
    v_mov_b64 v[88:89], 0
    v_mov_b64 v[90:91], 0
    v_mov_b64 v[92:93], 0
    v_mov_b64 v[94:95], 0
    v_mov_b64 v[96:97], 0
    v_mov_b64 v[98:99], 0
    v_mov_b64 v[100:101], 0
    v_mov_b64 v[102:103], 0
    v_mov_b64 v[104:105], 0
    v_mov_b64 v[106:107], 0
    v_mov_b64 v[108:109], 0
    v_mov_b64 v[110:111], 0
    v_mov_b64 v[112:113], 0
    v_mov_b64 v[114:115], 0
    v_mov_b64 v[116:117], 0
    v_mov_b64 v[118:119], 0
    v_mov_b64 v[120:121], 0
    v_mov_b64 v[122:123], 0
    v_mov_b64 v[124:125], 0
    v_mov_b64 v[126:127], 0
    v_mov_b64 v[128:129], 0
    v_mov_b64 v[130:131], 0
    v_mov_b64 v[132:133], 0
    v_mov_b64 v[134:135], 0
    v_mov_b64 v[136:137], 0
    v_mov_b64 v[138:139], 0
    v_mov_b64 v[140:141], 0
    v_mov_b64 v[142:143], 0
    v_mov_b64 v[144:145], 0
    v_mov_b64 v[146:147], 0
    v_mov_b64 v[148:149], 0
    v_mov_b64 v[150:151], 0
    s_lshl_b32 s34, s27, 7
    s_add_u32 s34, s34, s25
    s_mul_i32 s35, s27, 245760
    s_add_u32 s35, s35, s26
    s_add_u32 s36, s22, 49152
    s_add_u32 s37, s23, 49152
    s_add_u32 s27, s27, 1
    s_cmp_eq_u32 s27, 10
    s_cselect_b32 s27, 0, s27
    s_add_u32 m0, s36, 0
    s_nop 0
    buffer_load_dwordx4 v16, s[8:11], s34 offen lds
    s_add_u32 m0, s37, 0
    s_nop 0
    buffer_load_dwordx4 v20, s[12:15], s35 offen lds
    s_add_u32 m0, s36, 1024
    s_nop 0
    buffer_load_dwordx4 v17, s[8:11], s34 offen lds
    s_add_u32 m0, s37, 1024
    s_nop 0
    buffer_load_dwordx4 v21, s[12:15], s35 offen lds
    s_add_u32 m0, s36, 2048
    s_nop 0
    buffer_load_dwordx4 v18, s[8:11], s34 offen lds
    s_add_u32 m0, s36, 3072
    s_nop 0
    buffer_load_dwordx4 v19, s[8:11], s34 offen lds
    s_waitcnt lgkmcnt(0)
    v_lshrrev_b32 v8, 4, v1
    v_bfe_u32 v9, v1, 2, 2
    v_lshl_add_u32 v10, v8, 3, v9
    v_lshlrev_b32 v10, 8, v10
    v_add_u32 v10, 32768, v10
    v_and_b32 v8, 1, v8
    v_lshl_add_u32 v9, v8, 2, v9
    v_lshlrev_b32 v9, 5, v9
    v_and_b32 v8, 3, v1
    v_lshlrev_b32 v8, 3, v8
    v_bfe_u32 v11, s40, v8, 5
    v_lshlrev_b32 v11, 3, v11
    v_xor_b32 v11, v11, v9
    v_add_u32 v4, v10, v11
    v_bfe_u32 v11, s41, v8, 5
    v_lshlrev_b32 v11, 3, v11
    v_xor_b32 v11, v11, v9
    v_add_u32 v5, v10, v11
    v_bfe_u32 v11, s42, v8, 5
    v_lshlrev_b32 v11, 3, v11
    v_xor_b32 v11, v11, v9
    v_add_u32 v6, v10, v11
    v_bfe_u32 v11, s43, v8, 5
    v_lshlrev_b32 v11, 3, v11
    v_xor_b32 v11, v11, v9
    v_add_u32 v7, v10, v11
    s_mov_b32 s21, 0
    s_cmp_ge_u32 s31, 5
    s_cbranch_scc1 L_p1_v
    s_mov_b32 s58, 0x3ea52b5c
    s_mov_b32 s59, 0x3ea52b5c
    s_lshl_b32 s36, s29, 1
    s_lshr_b32 s37, s94, 2
    s_add_u32 s36, s36, s37
    s_mul_i32 s36, s36, 5120
    s_lshl_b32 s35, s28, 2
    s_add_u32 s35, s35, s61
    s_mul_i32 s35, s35, 655360
    s_add_u32 s35, s35, s36
    s_lshl_b32 s34, s35, 1
    s_add_u32 s35, s35, 10485760
    s_mov_b32 s36, 81920
    s_cmp_le_u32 s31, 2
    s_cselect_b32 s68, s36, 163840
    s_cselect_b32 s70, s35, s34
    s_cselect_b32 s72, s58, 1.0
    s_mov_b32 s73, s72
    s_cmp_le_u32 s31, 1
    s_cselect_b32 s69, s36, 163840
    s_cselect_b32 s71, s35, s34
    s_cselect_b32 s74, s58, 1.0
    s_mov_b32 s75, s74
    s_bfe_u32 s36, s94, 0x10001
    s_lshl_b32 s37, s36, 9
    s_add_u32 s37, s37, 4096
    s_lshl_b32 s36, s36, 11
    v_and_b32 v8, 15, v1
    v_lshlrev_b32 v8, 4, v8
    v_and_b32 v9, 48, v1
    v_lshrrev_b64 v[10:11], v9, s[44:45]
    v_and_b32 v11, 31, v10
    v_mul_lo_u32 v11, v11, s68
    v_bfe_u32 v14, v10, 8, 5
    v_mul_lo_u32 v153, v14, s68
    v_bfe_u32 v13, v10, 6, 1
    v_lshl_add_u32 v13, v13, 9, s36
    v_and_b32 v10, 32, v10
    v_cmp_ne_u32 s[48:49], 0, v10
    v_mov_b32 v14, s37
    v_add_u32 v15, 1024, v13
    v_cndmask_b32 v13, v13, v14, s[48:49]
    v_cndmask_b32 v15, v15, v14, s[48:49]
    v_add3_u32 v152, v11, v13, v8
    v_add3_u32 v153, v153, v15, v8
    v_lshrrev_b64 v[10:11], v9, s[46:47]
    v_and_b32 v11, 31, v10
    v_mul_lo_u32 v11, v11, s69
    v_bfe_u32 v14, v10, 8, 5
    v_mul_lo_u32 v155, v14, s69
    v_bfe_u32 v13, v10, 6, 1
    v_lshl_add_u32 v13, v13, 9, s36
    v_and_b32 v10, 32, v10
    v_cmp_ne_u32 s[50:51], 0, v10
    v_mov_b32 v14, s37
    v_add_u32 v15, 1024, v13
    v_cndmask_b32 v13, v13, v14, s[50:51]
    v_cndmask_b32 v15, v15, v14, s[50:51]
    v_add3_u32 v154, v11, v13, v8
    v_add3_u32 v155, v155, v15, v8
    s_and_b32 s40, s2, 7
    s_lshl_b32 s40, s40, 8
    s_add_u32 s40, s40, 22609920
    v_and_b32 v245, 31, v1
    v_lshl_add_u32 v245, v245, 3, s40
    s_mov_b32 s16, s88
    s_mov_b32 s17, s89
    s_mov_b32 s18, 15728640
    s_mov_b32 s19, 0x20000
    s_mov_b32 s87, 98304
    s_waitcnt vmcnt(6)
    s_barrier
    ds_read_b128 v[24:27], v2 offset:0
    ds_read_b64_tr_b16 v[40:41], v4 offset:0
    ds_read_b64_tr_b16 v[42:43], v4 offset:1024
    ds_read_b64_tr_b16 v[44:45], v5 offset:0
    ds_read_b64_tr_b16 v[46:47], v5 offset:1024
    ds_read_b128 v[28:31], v3 offset:1024
    ds_read_b128 v[32:35], v2 offset:4096
    ds_read_b128 v[36:39], v3 offset:5120
    ds_read_b64_tr_b16 v[48:49], v6 offset:0
    ds_read_b64_tr_b16 v[50:51], v6 offset:1024
    ds_read_b64_tr_b16 v[52:53], v7 offset:0
    ds_read_b64_tr_b16 v[54:55], v7 offset:1024
.p2align 5
L_p1_qk:
    s_waitcnt lgkmcnt(4)
    v_mfma_f32_16x16x32_bf16 v[88:91], v[40:43], v[24:27], v[88:91]
    ds_read_b128 v[56:59], v3 offset:0
    ds_read_b64_tr_b16 v[72:73], v4 offset:8192
    s_lshl_b32 s34, s27, 7
    s_add_u32 s34, s34, s25
    s_mul_i32 s35, s27, 245760
    s_add_u32 s35, s35, s26
    s_add_u32 s36, s22, s87
    v_mfma_f32_16x16x32_bf16 v[92:95], v[44:47], v[24:27], v[92:95]
    ds_read_b64_tr_b16 v[74:75], v4 offset:9216
    s_add_u32 s37, s23, s87
    s_add_u32 s27, s27, 1
    s_cmp_eq_u32 s27, 10
    s_cselect_b32 s27, 0, s27
    v_mfma_f32_16x16x32_bf16 v[108:111], v[44:47], v[28:31], v[108:111]
    ds_read_b64_tr_b16 v[76:77], v5 offset:8192
    s_mov_b32 s85, s84
    s_add_u32 s84, s84, 49152
    s_cmp_eq_u32 s84, 147456
    s_cselect_b32 s84, 0, s84
    s_sub_u32 s86, s84, s85
    v_mfma_f32_16x16x32_bf16 v[104:107], v[40:43], v[28:31], v[104:107]
    ds_read_b64_tr_b16 v[78:79], v5 offset:9216
    s_add_u32 m0, s36, 0
    v_mfma_f32_16x16x32_bf16 v[120:123], v[40:43], v[32:35], v[120:123]
    buffer_load_dwordx4 v16, s[8:11], s34 offen lds
    ds_read_b128 v[60:63], v2 offset:1024
    v_mfma_f32_16x16x32_bf16 v[124:127], v[44:47], v[32:35], v[124:127]
    ds_read_b128 v[64:67], v3 offset:4096
    ds_read_b128 v[68:71], v2 offset:5120
    s_add_u32 m0, s37, 0
    v_mfma_f32_16x16x32_bf16 v[140:143], v[44:47], v[36:39], v[140:143]
    buffer_load_dwordx4 v20, s[12:15], s35 offen lds
    ds_read_b64_tr_b16 v[80:81], v6 offset:8192
    v_mfma_f32_16x16x32_bf16 v[136:139], v[40:43], v[36:39], v[136:139]
    ds_read_b64_tr_b16 v[82:83], v6 offset:9216
    s_add_u32 m0, s36, 1024
    s_waitcnt lgkmcnt(10)
    v_mfma_f32_16x16x32_bf16 v[96:99], v[48:51], v[24:27], v[96:99]
    buffer_load_dwordx4 v17, s[8:11], s34 offen lds
    ds_read_b64_tr_b16 v[84:85], v7 offset:8192
    v_mfma_f32_16x16x32_bf16 v[100:103], v[52:55], v[24:27], v[100:103]
    ds_read_b64_tr_b16 v[86:87], v7 offset:9216
    s_add_u32 m0, s37, 1024
    v_mfma_f32_16x16x32_bf16 v[116:119], v[52:55], v[28:31], v[116:119]
    buffer_load_dwordx4 v21, s[12:15], s35 offen lds
    v_add_u32 v2, s86, v2
    v_mfma_f32_16x16x32_bf16 v[112:115], v[48:51], v[28:31], v[112:115]
    s_add_u32 m0, s36, 2048
    v_add_u32 v3, s86, v3
    v_mfma_f32_16x16x32_bf16 v[128:131], v[48:51], v[32:35], v[128:131]
    buffer_load_dwordx4 v18, s[8:11], s34 offen lds
    v_add_u32 v4, s86, v4
    v_mfma_f32_16x16x32_bf16 v[132:135], v[52:55], v[32:35], v[132:135]
    s_add_u32 m0, s36, 3072
    v_add_u32 v5, s86, v5
    v_mfma_f32_16x16x32_bf16 v[148:151], v[52:55], v[36:39], v[148:151]
    buffer_load_dwordx4 v19, s[8:11], s34 offen lds
    v_add_u32 v6, s86, v6
    v_mfma_f32_16x16x32_bf16 v[144:147], v[48:51], v[36:39], v[144:147]
    v_add_u32 v7, s86, v7
    s_waitcnt lgkmcnt(4)
    v_mfma_f32_16x16x32_bf16 v[88:91], v[72:75], v[56:59], v[88:91]
    v_mfma_f32_16x16x32_bf16 v[92:95], v[76:79], v[56:59], v[92:95]
    v_mfma_f32_16x16x32_bf16 v[108:111], v[76:79], v[60:63], v[108:111]
    v_mfma_f32_16x16x32_bf16 v[104:107], v[72:75], v[60:63], v[104:107]
    v_mfma_f32_16x16x32_bf16 v[120:123], v[72:75], v[64:67], v[120:123]
    v_mfma_f32_16x16x32_bf16 v[124:127], v[76:79], v[64:67], v[124:127]
    s_mov_b32 s87, s85
    s_waitcnt vmcnt(6) lgkmcnt(0)
    s_barrier
    v_mfma_f32_16x16x32_bf16 v[140:143], v[76:79], v[68:71], v[140:143]
    ds_read_b128 v[24:27], v2 offset:0
    ds_read_b64_tr_b16 v[40:41], v4 offset:0
    v_mfma_f32_16x16x32_bf16 v[136:139], v[72:75], v[68:71], v[136:139]
    ds_read_b64_tr_b16 v[42:43], v4 offset:1024
    ds_read_b64_tr_b16 v[44:45], v5 offset:0
    v_mfma_f32_16x16x32_bf16 v[96:99], v[80:83], v[56:59], v[96:99]
    ds_read_b64_tr_b16 v[46:47], v5 offset:1024
    ds_read_b128 v[28:31], v3 offset:1024
    v_mfma_f32_16x16x32_bf16 v[100:103], v[84:87], v[56:59], v[100:103]
    ds_read_b128 v[32:35], v2 offset:4096
    ds_read_b128 v[36:39], v3 offset:5120
    v_mfma_f32_16x16x32_bf16 v[116:119], v[84:87], v[60:63], v[116:119]
    ds_read_b64_tr_b16 v[48:49], v6 offset:0
    ds_read_b64_tr_b16 v[50:51], v6 offset:1024
    v_mfma_f32_16x16x32_bf16 v[112:115], v[80:83], v[60:63], v[112:115]
    ds_read_b64_tr_b16 v[52:53], v7 offset:0
    ds_read_b64_tr_b16 v[54:55], v7 offset:1024
    v_mfma_f32_16x16x32_bf16 v[128:131], v[80:83], v[64:67], v[128:131]
    v_mfma_f32_16x16x32_bf16 v[132:135], v[84:87], v[64:67], v[132:135]
    s_cmp_eq_u32 s21, 2
    s_cbranch_scc0 L_h1_qk
    v_mov_b32 v8, 0
    global_load_dwordx2 v[160:161], v8, s[92:93] sc1
L_h1_qk:
    s_cmp_eq_u32 s21, 4
    s_cbranch_scc0 L_h2_qk
    v_readfirstlane_b32 s90, v160
    v_readfirstlane_b32 s91, v161
    s_cmp_lg_u32 s94, 0
    s_cbranch_scc1 L_h2_qk
    s_cmp_eq_u32 s90, 0
    s_cbranch_scc1 L_pub_qk
    s_getreg_b32 s34, hwreg(HW_REG_XCC_ID, 0, 4)
    s_xor_b32 s34, s34, s90
    s_and_b32 s35, s2, 7
    s_lshl_b32 s35, s35, 8
    s_and_b32 s36, s2, 0xf8
    s_add_u32 s35, s35, s36
    s_add_u32 s35, s35, 22611968
    v_mov_b32 v8, s35
    v_mov_b32 v10, s34
    v_mov_b32 v11, s91
    s_mov_b64 exec, 1
    global_store_dwordx2 v8, v[10:11], s[88:89] sc1
    s_mov_b64 exec, -1
L_pub_qk:
L_h2_qk:
    v_mfma_f32_16x16x32_bf16 v[148:151], v[84:87], v[68:71], v[148:151]
    v_mfma_f32_16x16x32_bf16 v[144:147], v[80:83], v[68:71], v[144:147]
    s_add_u32 s21, s21, 1
    s_cmp_lg_u32 s21, 8
    s_cbranch_scc1 L_p1_qk
    s_waitcnt lgkmcnt(4)
    v_mfma_f32_16x16x32_bf16 v[88:91], v[40:43], v[24:27], v[88:91]
    ds_read_b128 v[56:59], v3 offset:0
    v_mfma_f32_16x16x32_bf16 v[92:95], v[44:47], v[24:27], v[92:95]
    ds_read_b64_tr_b16 v[72:73], v4 offset:8192
    v_mfma_f32_16x16x32_bf16 v[108:111], v[44:47], v[28:31], v[108:111]
    ds_read_b64_tr_b16 v[74:75], v4 offset:9216
    v_mfma_f32_16x16x32_bf16 v[104:107], v[40:43], v[28:31], v[104:107]
    ds_read_b64_tr_b16 v[76:77], v5 offset:8192
    ds_read_b64_tr_b16 v[78:79], v5 offset:9216
    v_mfma_f32_16x16x32_bf16 v[120:123], v[40:43], v[32:35], v[120:123]
    ds_read_b128 v[60:63], v2 offset:1024
    v_mfma_f32_16x16x32_bf16 v[124:127], v[44:47], v[32:35], v[124:127]
    ds_read_b128 v[64:67], v3 offset:4096
    v_mfma_f32_16x16x32_bf16 v[140:143], v[44:47], v[36:39], v[140:143]
    ds_read_b128 v[68:71], v2 offset:5120
    v_mfma_f32_16x16x32_bf16 v[136:139], v[40:43], v[36:39], v[136:139]
    ds_read_b64_tr_b16 v[80:81], v6 offset:8192
    ds_read_b64_tr_b16 v[82:83], v6 offset:9216
    s_waitcnt lgkmcnt(10)
    v_mfma_f32_16x16x32_bf16 v[96:99], v[48:51], v[24:27], v[96:99]
    ds_read_b64_tr_b16 v[84:85], v7 offset:8192
    ds_read_b64_tr_b16 v[86:87], v7 offset:9216
    s_mov_b32 s85, s84
    s_add_u32 s84, s84, 49152
    s_cmp_eq_u32 s84, 147456
    s_cselect_b32 s84, 0, s84
    s_sub_u32 s86, s84, s85
    v_add_u32 v2, s86, v2
    v_mfma_f32_16x16x32_bf16 v[100:103], v[52:55], v[24:27], v[100:103]
    v_add_u32 v3, s86, v3
    v_add_u32 v4, s86, v4
    v_add_u32 v5, s86, v5
    v_add_u32 v6, s86, v6
    v_add_u32 v7, s86, v7
    v_mfma_f32_16x16x32_bf16 v[116:119], v[52:55], v[28:31], v[116:119]
    v_and_b32 v249, 31, v1
    v_bfe_u32 v250, v249, 2, 1
    v_and_b32 v251, 3, v249
    v_lshrrev_b32 v252, 3, v249
    v_lshl_add_u32 v251, v252, 2, v251
    v_mfma_f32_16x16x32_bf16 v[112:115], v[48:51], v[28:31], v[112:115]
    v_mul_u32_u24 v250, 10, v250
    v_add_u32 v250, v250, v251
    v_add_u32 v252, 6, v250
    v_cmp_gt_u32 vcc, 4, v250
    v_lshlrev_b32 v242, 4, v1
    s_nop 0
    v_mfma_f32_16x16x32_bf16 v[128:131], v[48:51], v[32:35], v[128:131]
    v_cndmask_b32 v252, v252, v250, vcc
    v_cmp_lt_u32 vcc, 13, v250
    v_subrev_u32 v243, 10, v250
    s_nop 0
    v_cndmask_b32 v252, v252, v243, vcc
    v_mfma_f32_16x16x32_bf16 v[132:135], v[52:55], v[32:35], v[132:135]
    v_lshlrev_b32 v252, 4, v252
    v_lshrrev_b32 v243, 5, v1
    v_mul_u32_u24 v243, 320, v243
    v_add_u32 v243, v243, v252
    v_add_u32 v243, 5120, v243
    v_mfma_f32_16x16x32_bf16 v[148:151], v[52:55], v[36:39], v[148:151]
    v_cmp_eq_u32 vcc, 10, v251
    v_mov_b32 v244, 0xdddddddd
    v_mov_b32 v252, 0x3f803f80
    v_cndmask_b32 v252, 0, v252, vcc
    v_lshlrev_b32 v248, 4, v249
    v_mfma_f32_16x16x32_bf16 v[144:147], v[48:51], v[36:39], v[144:147]
    v_mov_b32 v168, v252
    v_mov_b32 v169, v252
    v_mov_b64 v[170:171], v[168:169]
    v_mov_b64 v[172:173], v[168:169]
    v_mov_b64 v[174:175], v[168:169]
    v_mov_b64 v[176:177], v[168:169]
    s_waitcnt lgkmcnt(4)
    v_mfma_f32_16x16x32_bf16 v[88:91], v[72:75], v[56:59], v[88:91]
    v_mfma_f32_16x16x32_bf16 v[92:95], v[76:79], v[56:59], v[92:95]
    v_mfma_f32_16x16x32_bf16 v[108:111], v[76:79], v[60:63], v[108:111]
    v_mfma_f32_16x16x32_bf16 v[104:107], v[72:75], v[60:63], v[104:107]
    v_mfma_f32_16x16x32_bf16 v[120:123], v[72:75], v[64:67], v[120:123]
    v_mfma_f32_16x16x32_bf16 v[124:127], v[76:79], v[64:67], v[124:127]
    s_mov_b32 s87, s85
    s_waitcnt vmcnt(0) lgkmcnt(0)
    s_barrier
    v_mfma_f32_16x16x32_bf16 v[140:143], v[76:79], v[68:71], v[140:143]
    ds_read_b128 v[24:27], v2 offset:0
    ds_read_b64_tr_b16 v[40:41], v4 offset:0
    v_mfma_f32_16x16x32_bf16 v[136:139], v[72:75], v[68:71], v[136:139]
    ds_read_b64_tr_b16 v[42:43], v4 offset:1024
    ds_read_b64_tr_b16 v[44:45], v5 offset:0
    v_mfma_f32_16x16x32_bf16 v[96:99], v[80:83], v[56:59], v[96:99]
    ds_read_b64_tr_b16 v[46:47], v5 offset:1024
    ds_read_b128 v[28:31], v3 offset:1024
    v_mfma_f32_16x16x32_bf16 v[100:103], v[84:87], v[56:59], v[100:103]
    ds_read_b128 v[32:35], v2 offset:4096
    ds_read_b128 v[36:39], v3 offset:5120
    v_mfma_f32_16x16x32_bf16 v[116:119], v[84:87], v[60:63], v[116:119]
    ds_read_b64_tr_b16 v[48:49], v6 offset:0
    ds_read_b64_tr_b16 v[50:51], v6 offset:1024
    v_mfma_f32_16x16x32_bf16 v[112:115], v[80:83], v[60:63], v[112:115]
    ds_read_b64_tr_b16 v[52:53], v7 offset:0
    ds_read_b64_tr_b16 v[54:55], v7 offset:1024
    v_mfma_f32_16x16x32_bf16 v[128:131], v[80:83], v[64:67], v[128:131]
    s_and_b32 s35, s2, 7
    s_lshl_b32 s35, s35, 8
    s_add_u32 s35, s35, 22611968
    v_and_b32 v8, 31, v1
    v_lshl_add_u32 v8, v8, 3, s35
    global_load_dwordx2 v[166:167], v8, s[88:89] sc1
    v_lshlrev_b32 v9, 4, v1
    v_lshlrev_b32 v10, 3, v1
    global_load_dwordx4 v[232:235], v9, s[80:81]
    global_load_dwordx4 v[236:239], v9, s[80:81] offset:1024
    global_load_dwordx2 v[240:241], v10, s[80:81] offset:2048
    v_mov_b64 v[178:179], v[168:169]
    v_mov_b64 v[180:181], v[168:169]
    v_mov_b64 v[182:183], v[168:169]
    v_mov_b64 v[184:185], v[168:169]
    v_mov_b64 v[186:187], v[168:169]
    v_mov_b64 v[188:189], v[168:169]
    v_mov_b64 v[190:191], v[168:169]
    v_mfma_f32_16x16x32_bf16 v[132:135], v[84:87], v[64:67], v[132:135]
    v_mov_b64 v[192:193], v[168:169]
    v_mov_b64 v[194:195], v[168:169]
    v_mov_b64 v[196:197], v[168:169]
    v_mov_b64 v[198:199], v[168:169]
    v_mov_b64 v[200:201], 0
    v_mov_b64 v[202:203], 0
    v_mov_b64 v[204:205], 0
    v_mov_b64 v[206:207], 0
    v_mfma_f32_16x16x32_bf16 v[148:151], v[84:87], v[68:71], v[148:151]
    v_mov_b64 v[208:209], 0
    v_mov_b64 v[210:211], 0
    v_mov_b64 v[212:213], 0
    v_mov_b64 v[214:215], 0
    v_mov_b64 v[216:217], 0
    v_mov_b64 v[218:219], 0
    v_mov_b64 v[220:221], 0
    v_mov_b64 v[222:223], 0
    v_mfma_f32_16x16x32_bf16 v[144:147], v[80:83], v[68:71], v[144:147]
    v_mov_b64 v[224:225], 0
    v_mov_b64 v[226:227], 0
    v_mov_b64 v[228:229], 0
    v_mov_b64 v[230:231], 0
    v_mov_b32 v246, v242
    v_mov_b32 v247, v243
    v_lshrrev_b32 v254, 5, v1
    v_lshl_add_u32 v254, v254, 3, v248
    v_mov_b32 v253, v248
    s_waitcnt lgkmcnt(4)
    v_mfma_f32_16x16x32_bf16 v[88:91], v[40:43], v[24:27], v[88:91]
    ds_read_b128 v[56:59], v3 offset:0
    v_mfma_f32_16x16x32_bf16 v[92:95], v[44:47], v[24:27], v[92:95]
    ds_read_b64_tr_b16 v[72:73], v4 offset:8192
    v_mfma_f32_16x16x32_bf16 v[108:111], v[44:47], v[28:31], v[108:111]
    ds_read_b64_tr_b16 v[74:75], v4 offset:9216
    v_mfma_f32_16x16x32_bf16 v[104:107], v[40:43], v[28:31], v[104:107]
    ds_read_b64_tr_b16 v[76:77], v5 offset:8192
    ds_read_b64_tr_b16 v[78:79], v5 offset:9216
    v_mfma_f32_16x16x32_bf16 v[120:123], v[40:43], v[32:35], v[120:123]
    ds_read_b128 v[60:63], v2 offset:1024
    v_mfma_f32_16x16x32_bf16 v[124:127], v[44:47], v[32:35], v[124:127]
    ds_read_b128 v[64:67], v3 offset:4096
    v_mfma_f32_16x16x32_bf16 v[140:143], v[44:47], v[36:39], v[140:143]
    ds_read_b128 v[68:71], v2 offset:5120
    v_mfma_f32_16x16x32_bf16 v[136:139], v[40:43], v[36:39], v[136:139]
    ds_read_b64_tr_b16 v[80:81], v6 offset:8192
    ds_read_b64_tr_b16 v[82:83], v6 offset:9216
    s_waitcnt lgkmcnt(10)
    v_mfma_f32_16x16x32_bf16 v[96:99], v[48:51], v[24:27], v[96:99]
    v_mfma_f32_16x16x32_bf16 v[100:103], v[52:55], v[24:27], v[100:103]
    ds_read_b64_tr_b16 v[84:85], v7 offset:8192
    v_mfma_f32_16x16x32_bf16 v[116:119], v[52:55], v[28:31], v[116:119]
    v_mfma_f32_16x16x32_bf16 v[112:115], v[48:51], v[28:31], v[112:115]
    ds_read_b64_tr_b16 v[86:87], v7 offset:9216
    s_waitcnt lgkmcnt(0)
    v_mfma_f32_16x16x32_bf16 v[88:91], v[72:75], v[56:59], v[88:91]
    v_mfma_f32_16x16x32_bf16 v[92:95], v[76:79], v[56:59], v[92:95]
    v_mfma_f32_16x16x32_bf16 v[108:111], v[76:79], v[60:63], v[108:111]
    v_mfma_f32_16x16x32_bf16 v[104:107], v[72:75], v[60:63], v[104:107]
    v_mfma_f32_16x16x32_bf16 v[120:123], v[72:75], v[64:67], v[120:123]
    v_mfma_f32_16x16x32_bf16 v[124:127], v[76:79], v[64:67], v[124:127]
    v_mfma_f32_16x16x32_bf16 v[140:143], v[76:79], v[68:71], v[140:143]
    v_mfma_f32_16x16x32_bf16 v[136:139], v[72:75], v[68:71], v[136:139]
    v_mfma_f32_16x16x32_bf16 v[128:131], v[48:51], v[32:35], v[128:131]
    v_mfma_f32_16x16x32_bf16 v[132:135], v[52:55], v[32:35], v[132:135]
    s_waitcnt vmcnt(0)
    s_getreg_b32 s63, hwreg(HW_REG_XCC_ID, 0, 4)
    s_xor_b32 s42, s90, s63
    s_mov_b32 s43, s91
    v_cmp_eq_u64 vcc, s[42:43], v[166:167]
    v_mfma_f32_16x16x32_bf16 v[148:151], v[52:55], v[36:39], v[148:151]
    s_cmp_lg_u32 s90, 0
    s_cselect_b32 s63, 1, 0
    s_cmp_eq_u64 vcc, -1
    s_cselect_b32 s63, s63, 0
    s_mov_b32 s57, s63
    s_cmp_lg_u32 s57, 0
    v_mfma_f32_16x16x32_bf16 v[144:147], v[48:51], v[36:39], v[144:147]
    v_pk_mul_f32 v[88:89], v[88:89], s[72:73]
    v_pk_mul_f32 v[90:91], v[90:91], s[72:73]
    v_pk_mul_f32 v[92:93], v[92:93], s[72:73]
    v_pk_mul_f32 v[94:95], v[94:95], s[72:73]
    v_pk_mul_f32 v[104:105], v[104:105], s[72:73]
    v_mfma_f32_16x16x32_bf16 v[96:99], v[80:83], v[56:59], v[96:99]
    v_pk_mul_f32 v[106:107], v[106:107], s[72:73]
    v_pk_mul_f32 v[108:109], v[108:109], s[72:73]
    v_pk_mul_f32 v[110:111], v[110:111], s[72:73]
    v_pk_mul_f32 v[120:121], v[120:121], s[72:73]
    v_pk_mul_f32 v[122:123], v[122:123], s[72:73]
    v_pk_mul_f32 v[124:125], v[124:125], s[72:73]
    v_mfma_f32_16x16x32_bf16 v[100:103], v[84:87], v[56:59], v[100:103]
    v_pk_mul_f32 v[126:127], v[126:127], s[72:73]
    v_pk_mul_f32 v[136:137], v[136:137], s[72:73]
    v_pk_mul_f32 v[138:139], v[138:139], s[72:73]
    v_pk_mul_f32 v[140:141], v[140:141], s[72:73]
    v_pk_mul_f32 v[142:143], v[142:143], s[72:73]
    v_mfma_f32_16x16x32_bf16 v[116:119], v[84:87], v[60:63], v[116:119]
    v_cvt_pk_bf16_f32 v88, v88, v89
    v_cvt_pk_bf16_f32 v89, v90, v91
    v_cvt_pk_bf16_f32 v92, v92, v93
    v_cvt_pk_bf16_f32 v93, v94, v95
    v_cvt_pk_bf16_f32 v94, v120, v121
    v_cvt_pk_bf16_f32 v95, v122, v123
    v_mfma_f32_16x16x32_bf16 v[112:115], v[80:83], v[60:63], v[112:115]
    v_cvt_pk_bf16_f32 v122, v124, v125
    v_cvt_pk_bf16_f32 v123, v126, v127
    v_cndmask_b32 v90, v92, v94, s[48:49]
    v_cndmask_b32 v120, v94, v92, s[48:49]
    v_cndmask_b32 v91, v93, v95, s[48:49]
    v_mfma_f32_16x16x32_bf16 v[128:131], v[80:83], v[64:67], v[128:131]
    v_cndmask_b32 v121, v95, v93, s[48:49]
    s_cbranch_scc1 L_e0_12p
    buffer_store_dwordx4 v[88:91], v152, s[16:19], s70 offen offset:0 sc1
    s_branch L_e0_12d
L_e0_12p:
    buffer_store_dwordx4 v[88:91], v152, s[16:19], s70 offen offset:0
L_e0_12d:
    s_cbranch_scc1 L_e0_13p
    buffer_store_dwordx4 v[120:123], v153, s[16:19], s70 offen offset:0 sc1
    s_branch L_e0_13d
L_e0_13p:
    buffer_store_dwordx4 v[120:123], v153, s[16:19], s70 offen offset:0
L_e0_13d:
    v_cvt_pk_bf16_f32 v104, v104, v105
    v_cvt_pk_bf16_f32 v105, v106, v107
    v_cvt_pk_bf16_f32 v108, v108, v109
    v_mfma_f32_16x16x32_bf16 v[132:135], v[84:87], v[64:67], v[132:135]
    v_cvt_pk_bf16_f32 v109, v110, v111
    v_cvt_pk_bf16_f32 v110, v136, v137
    v_cvt_pk_bf16_f32 v111, v138, v139
    v_cvt_pk_bf16_f32 v138, v140, v141
    v_cvt_pk_bf16_f32 v139, v142, v143
    v_mfma_f32_16x16x32_bf16 v[148:151], v[84:87], v[68:71], v[148:151]
    v_cndmask_b32 v106, v108, v110, s[48:49]
    v_cndmask_b32 v136, v110, v108, s[48:49]
    v_cndmask_b32 v107, v109, v111, s[48:49]
    v_cndmask_b32 v137, v111, v109, s[48:49]
    s_cbranch_scc1 L_e0_26p
    buffer_store_dwordx4 v[104:107], v152, s[16:19], s70 offen offset:256 sc1
    s_branch L_e0_26d
L_e0_26p:
    buffer_store_dwordx4 v[104:107], v152, s[16:19], s70 offen offset:256
L_e0_26d:
    s_cbranch_scc1 L_e0_27p
    buffer_store_dwordx4 v[136:139], v153, s[16:19], s70 offen offset:256 sc1
    s_branch L_e0_27d
L_e0_27p:
    buffer_store_dwordx4 v[136:139], v153, s[16:19], s70 offen offset:256
L_e0_27d:
    v_mfma_f32_16x16x32_bf16 v[144:147], v[80:83], v[68:71], v[144:147]
    s_nop 7
    s_cmp_lg_u32 s57, 0
    v_pk_mul_f32 v[96:97], v[96:97], s[74:75]
    v_pk_mul_f32 v[98:99], v[98:99], s[74:75]
    v_pk_mul_f32 v[100:101], v[100:101], s[74:75]
    v_pk_mul_f32 v[102:103], v[102:103], s[74:75]
    v_pk_mul_f32 v[112:113], v[112:113], s[74:75]
    v_pk_mul_f32 v[114:115], v[114:115], s[74:75]
    v_pk_mul_f32 v[116:117], v[116:117], s[74:75]
    v_pk_mul_f32 v[118:119], v[118:119], s[74:75]
    v_pk_mul_f32 v[128:129], v[128:129], s[74:75]
    v_pk_mul_f32 v[130:131], v[130:131], s[74:75]
    v_pk_mul_f32 v[132:133], v[132:133], s[74:75]
    v_pk_mul_f32 v[134:135], v[134:135], s[74:75]
    v_pk_mul_f32 v[144:145], v[144:145], s[74:75]
    v_pk_mul_f32 v[146:147], v[146:147], s[74:75]
    v_pk_mul_f32 v[148:149], v[148:149], s[74:75]
    v_pk_mul_f32 v[150:151], v[150:151], s[74:75]
    v_cvt_pk_bf16_f32 v96, v96, v97
    v_cvt_pk_bf16_f32 v97, v98, v99
    v_cvt_pk_bf16_f32 v100, v100, v101
    v_cvt_pk_bf16_f32 v101, v102, v103
    v_cvt_pk_bf16_f32 v102, v128, v129
    v_cvt_pk_bf16_f32 v103, v130, v131
    v_cvt_pk_bf16_f32 v130, v132, v133
    v_cvt_pk_bf16_f32 v131, v134, v135
    v_cndmask_b32 v98, v100, v102, s[50:51]
    v_cndmask_b32 v128, v102, v100, s[50:51]
    v_cndmask_b32 v99, v101, v103, s[50:51]
    v_cndmask_b32 v129, v103, v101, s[50:51]
    s_cbranch_scc1 L_e1_12p
    buffer_store_dwordx4 v[96:99], v154, s[16:19], s71 offen offset:0 sc1
    s_branch L_e1_12d
L_e1_12p:
    buffer_store_dwordx4 v[96:99], v154, s[16:19], s71 offen offset:0
L_e1_12d:
    s_cbranch_scc1 L_e1_13p
    buffer_store_dwordx4 v[128:131], v155, s[16:19], s71 offen offset:0 sc1
    s_branch L_e1_13d
L_e1_13p:
    buffer_store_dwordx4 v[128:131], v155, s[16:19], s71 offen offset:0
L_e1_13d:
    v_cvt_pk_bf16_f32 v112, v112, v113
    v_cvt_pk_bf16_f32 v113, v114, v115
    v_cvt_pk_bf16_f32 v116, v116, v117
    v_cvt_pk_bf16_f32 v117, v118, v119
    v_cvt_pk_bf16_f32 v118, v144, v145
    v_cvt_pk_bf16_f32 v119, v146, v147
    v_cvt_pk_bf16_f32 v146, v148, v149
    v_cvt_pk_bf16_f32 v147, v150, v151
    v_cndmask_b32 v114, v116, v118, s[50:51]
    v_cndmask_b32 v144, v118, v116, s[50:51]
    v_cndmask_b32 v115, v117, v119, s[50:51]
    v_cndmask_b32 v145, v119, v117, s[50:51]
    s_cbranch_scc1 L_e1_26p
    buffer_store_dwordx4 v[112:115], v154, s[16:19], s71 offen offset:256 sc1
    s_branch L_e1_26d
L_e1_26p:
    buffer_store_dwordx4 v[112:115], v154, s[16:19], s71 offen offset:256
L_e1_26d:
    s_cbranch_scc1 L_e1_27p
    buffer_store_dwordx4 v[144:147], v155, s[16:19], s71 offen offset:256 sc1
    s_branch L_e1_27d
L_e1_27p:
    buffer_store_dwordx4 v[144:147], v155, s[16:19], s71 offen offset:256
L_e1_27d:
    s_branch L_p1_done
L_p1_v:
    s_lshl_b32 s36, s29, 1
    s_lshr_b32 s37, s94, 2
    s_add_u32 s36, s36, s37
    s_mul_i32 s35, s36, 10240
    s_bfe_u32 s36, s94, 0x10001
    s_mul_i32 s36, s36, 2560
    s_add_u32 s35, s35, s36
    s_lshl_b32 s36, s28, 2
    s_add_u32 s36, s36, s61
    s_mul_i32 s36, s36, 1310720
    s_add_u32 s35, s35, s36
    s_add_u32 s56, s35, 5120
    s_sub_u32 s36, s31, 5
    s_lshl_b32 s36, s36, 6
    s_mov_b32 s34, 163840
    v_and_b32 v8, 15, v1
    v_add_u32 v8, s36, v8
    v_lshrrev_b32 v9, 4, v1
    v_mul_u32_u24 v9, 320, v9
    v_mul_u32_u24 v10, 3277, v8
    v_lshrrev_b32 v10, 16, v10
    v_mul_u32_u24 v11, 20, v10
    v_sub_u32 v11, v8, v11
    v_mul_lo_u32 v10, v10, s34
    v_add_u32 v12, 6, v11
    v_cmp_gt_u32 vcc, 4, v11
    v_subrev_u32 v13, 10, v11
    v_add_u32 v8, 16, v8
    v_cndmask_b32 v12, v12, v11, vcc
    v_cmp_lt_u32 vcc, 13, v11
    v_add_u32 v10, v10, v9
    s_nop 0
    v_cndmask_b32 v12, v12, v13, vcc
    v_lshl_add_u32 v152, v12, 4, v10
    v_cmp_lt_u32 vcc, 175, v8
    v_mov_b32 v12, 0x7f000000
    s_nop 0
    v_cndmask_b32 v152, v152, v12, vcc
    v_mul_u32_u24 v10, 3277, v8
    v_lshrrev_b32 v10, 16, v10
    v_mul_u32_u24 v11, 20, v10
    v_sub_u32 v11, v8, v11
    v_mul_lo_u32 v10, v10, s34
    v_add_u32 v12, 6, v11
    v_cmp_gt_u32 vcc, 4, v11
    v_subrev_u32 v13, 10, v11
    v_add_u32 v8, 16, v8
    v_cndmask_b32 v12, v12, v11, vcc
    v_cmp_lt_u32 vcc, 13, v11
    v_add_u32 v10, v10, v9
    s_nop 0
    v_cndmask_b32 v12, v12, v13, vcc
    v_lshl_add_u32 v153, v12, 4, v10
    v_cmp_lt_u32 vcc, 175, v8
    v_mov_b32 v12, 0x7f000000
    s_nop 0
    v_cndmask_b32 v153, v153, v12, vcc
    v_mul_u32_u24 v10, 3277, v8
    v_lshrrev_b32 v10, 16, v10
    v_mul_u32_u24 v11, 20, v10
    v_sub_u32 v11, v8, v11
    v_mul_lo_u32 v10, v10, s34
    v_add_u32 v12, 6, v11
    v_cmp_gt_u32 vcc, 4, v11
    v_subrev_u32 v13, 10, v11
    v_add_u32 v8, 16, v8
    v_cndmask_b32 v12, v12, v11, vcc
    v_cmp_lt_u32 vcc, 13, v11
    v_add_u32 v10, v10, v9
    s_nop 0
    v_cndmask_b32 v12, v12, v13, vcc
    v_lshl_add_u32 v154, v12, 4, v10
    v_cmp_lt_u32 vcc, 175, v8
    v_mov_b32 v12, 0x7f000000
    s_nop 0
    v_cndmask_b32 v154, v154, v12, vcc
    v_mul_u32_u24 v10, 3277, v8
    v_lshrrev_b32 v10, 16, v10
    v_mul_u32_u24 v11, 20, v10
    v_sub_u32 v11, v8, v11
    v_mul_lo_u32 v10, v10, s34
    v_add_u32 v12, 6, v11
    v_cmp_gt_u32 vcc, 4, v11
    v_subrev_u32 v13, 10, v11
    v_add_u32 v8, 16, v8
    v_cndmask_b32 v12, v12, v11, vcc
    v_cmp_lt_u32 vcc, 13, v11
    v_add_u32 v10, v10, v9
    s_nop 0
    v_cndmask_b32 v12, v12, v13, vcc
    v_lshl_add_u32 v155, v12, 4, v10
    v_cmp_lt_u32 vcc, 175, v8
    v_mov_b32 v12, 0x7f000000
    s_nop 0
    v_cndmask_b32 v155, v155, v12, vcc
    s_and_b32 s40, s2, 7
    s_lshl_b32 s40, s40, 8
    s_add_u32 s40, s40, 22609920
    v_and_b32 v245, 31, v1
    v_lshl_add_u32 v245, v245, 3, s40
    s_mov_b32 s16, s88
    s_mov_b32 s17, s89
    s_mov_b32 s18, 15728640
    s_mov_b32 s19, 0x20000
    s_mov_b32 s87, 98304
    s_waitcnt vmcnt(6)
    s_barrier
    ds_read_b128 v[24:27], v2 offset:0
    ds_read_b64_tr_b16 v[40:41], v4 offset:0
    ds_read_b64_tr_b16 v[42:43], v4 offset:1024
    ds_read_b64_tr_b16 v[44:45], v5 offset:0
    ds_read_b64_tr_b16 v[46:47], v5 offset:1024
    ds_read_b128 v[28:31], v3 offset:2048
    ds_read_b128 v[32:35], v2 offset:4096
    ds_read_b128 v[36:39], v3 offset:6144
    ds_read_b64_tr_b16 v[48:49], v6 offset:0
    ds_read_b64_tr_b16 v[50:51], v6 offset:1024
    ds_read_b64_tr_b16 v[52:53], v7 offset:0
    ds_read_b64_tr_b16 v[54:55], v7 offset:1024
.p2align 5
L_p1_vv:
    s_waitcnt lgkmcnt(4)
    v_mfma_f32_16x16x32_bf16 v[88:91], v[24:27], v[40:43], v[88:91]
    ds_read_b128 v[56:59], v3 offset:0
    ds_read_b64_tr_b16 v[72:73], v4 offset:8192
    s_lshl_b32 s34, s27, 7
    s_add_u32 s34, s34, s25
    s_mul_i32 s35, s27, 245760
    s_add_u32 s35, s35, s26
    s_add_u32 s36, s22, s87
    v_mfma_f32_16x16x32_bf16 v[92:95], v[24:27], v[44:47], v[92:95]
    ds_read_b64_tr_b16 v[74:75], v4 offset:9216
    s_add_u32 s37, s23, s87
    s_add_u32 s27, s27, 1
    s_cmp_eq_u32 s27, 10
    s_cselect_b32 s27, 0, s27
    v_mfma_f32_16x16x32_bf16 v[108:111], v[28:31], v[44:47], v[108:111]
    ds_read_b64_tr_b16 v[76:77], v5 offset:8192
    s_mov_b32 s85, s84
    s_add_u32 s84, s84, 49152
    s_cmp_eq_u32 s84, 147456
    s_cselect_b32 s84, 0, s84
    s_sub_u32 s86, s84, s85
    v_mfma_f32_16x16x32_bf16 v[104:107], v[28:31], v[40:43], v[104:107]
    ds_read_b64_tr_b16 v[78:79], v5 offset:9216
    s_add_u32 m0, s36, 0
    v_mfma_f32_16x16x32_bf16 v[120:123], v[32:35], v[40:43], v[120:123]
    buffer_load_dwordx4 v16, s[8:11], s34 offen lds
    ds_read_b128 v[60:63], v2 offset:2048
    v_mfma_f32_16x16x32_bf16 v[124:127], v[32:35], v[44:47], v[124:127]
    ds_read_b128 v[64:67], v3 offset:4096
    ds_read_b128 v[68:71], v2 offset:6144
    s_add_u32 m0, s37, 0
    v_mfma_f32_16x16x32_bf16 v[140:143], v[36:39], v[44:47], v[140:143]
    buffer_load_dwordx4 v20, s[12:15], s35 offen lds
    ds_read_b64_tr_b16 v[80:81], v6 offset:8192
    v_mfma_f32_16x16x32_bf16 v[136:139], v[36:39], v[40:43], v[136:139]
    ds_read_b64_tr_b16 v[82:83], v6 offset:9216
    s_add_u32 m0, s36, 1024
    s_waitcnt lgkmcnt(10)
    v_mfma_f32_16x16x32_bf16 v[96:99], v[24:27], v[48:51], v[96:99]
    buffer_load_dwordx4 v17, s[8:11], s34 offen lds
    ds_read_b64_tr_b16 v[84:85], v7 offset:8192
    v_mfma_f32_16x16x32_bf16 v[100:103], v[24:27], v[52:55], v[100:103]
    ds_read_b64_tr_b16 v[86:87], v7 offset:9216
    s_add_u32 m0, s37, 1024
    v_mfma_f32_16x16x32_bf16 v[116:119], v[28:31], v[52:55], v[116:119]
    buffer_load_dwordx4 v21, s[12:15], s35 offen lds
    v_add_u32 v2, s86, v2
    v_mfma_f32_16x16x32_bf16 v[112:115], v[28:31], v[48:51], v[112:115]
    s_add_u32 m0, s36, 2048
    v_add_u32 v3, s86, v3
    v_mfma_f32_16x16x32_bf16 v[128:131], v[32:35], v[48:51], v[128:131]
    buffer_load_dwordx4 v18, s[8:11], s34 offen lds
    v_add_u32 v4, s86, v4
    v_mfma_f32_16x16x32_bf16 v[132:135], v[32:35], v[52:55], v[132:135]
    s_add_u32 m0, s36, 3072
    v_add_u32 v5, s86, v5
    v_mfma_f32_16x16x32_bf16 v[148:151], v[36:39], v[52:55], v[148:151]
    buffer_load_dwordx4 v19, s[8:11], s34 offen lds
    v_add_u32 v6, s86, v6
    v_mfma_f32_16x16x32_bf16 v[144:147], v[36:39], v[48:51], v[144:147]
    v_add_u32 v7, s86, v7
    s_waitcnt lgkmcnt(4)
    v_mfma_f32_16x16x32_bf16 v[88:91], v[56:59], v[72:75], v[88:91]
    v_mfma_f32_16x16x32_bf16 v[92:95], v[56:59], v[76:79], v[92:95]
    v_mfma_f32_16x16x32_bf16 v[108:111], v[60:63], v[76:79], v[108:111]
    v_mfma_f32_16x16x32_bf16 v[104:107], v[60:63], v[72:75], v[104:107]
    v_mfma_f32_16x16x32_bf16 v[120:123], v[64:67], v[72:75], v[120:123]
    v_mfma_f32_16x16x32_bf16 v[124:127], v[64:67], v[76:79], v[124:127]
    s_mov_b32 s87, s85
    s_waitcnt vmcnt(6) lgkmcnt(0)
    s_barrier
    v_mfma_f32_16x16x32_bf16 v[140:143], v[68:71], v[76:79], v[140:143]
    ds_read_b128 v[24:27], v2 offset:0
    ds_read_b64_tr_b16 v[40:41], v4 offset:0
    v_mfma_f32_16x16x32_bf16 v[136:139], v[68:71], v[72:75], v[136:139]
    ds_read_b64_tr_b16 v[42:43], v4 offset:1024
    ds_read_b64_tr_b16 v[44:45], v5 offset:0
    v_mfma_f32_16x16x32_bf16 v[96:99], v[56:59], v[80:83], v[96:99]
    ds_read_b64_tr_b16 v[46:47], v5 offset:1024
    ds_read_b128 v[28:31], v3 offset:2048
    v_mfma_f32_16x16x32_bf16 v[100:103], v[56:59], v[84:87], v[100:103]
    ds_read_b128 v[32:35], v2 offset:4096
    ds_read_b128 v[36:39], v3 offset:6144
    v_mfma_f32_16x16x32_bf16 v[116:119], v[60:63], v[84:87], v[116:119]
    ds_read_b64_tr_b16 v[48:49], v6 offset:0
    ds_read_b64_tr_b16 v[50:51], v6 offset:1024
    v_mfma_f32_16x16x32_bf16 v[112:115], v[60:63], v[80:83], v[112:115]
    ds_read_b64_tr_b16 v[52:53], v7 offset:0
    ds_read_b64_tr_b16 v[54:55], v7 offset:1024
    v_mfma_f32_16x16x32_bf16 v[128:131], v[64:67], v[80:83], v[128:131]
    v_mfma_f32_16x16x32_bf16 v[132:135], v[64:67], v[84:87], v[132:135]
    s_cmp_eq_u32 s21, 2
    s_cbranch_scc0 L_h1_vv
    v_mov_b32 v8, 0
    global_load_dwordx2 v[160:161], v8, s[92:93] sc1
L_h1_vv:
    s_cmp_eq_u32 s21, 4
    s_cbranch_scc0 L_h2_vv
    v_readfirstlane_b32 s90, v160
    v_readfirstlane_b32 s91, v161
    s_cmp_lg_u32 s94, 0
    s_cbranch_scc1 L_h2_vv
    s_cmp_eq_u32 s90, 0
    s_cbranch_scc1 L_pub_vv
    s_getreg_b32 s34, hwreg(HW_REG_XCC_ID, 0, 4)
    s_xor_b32 s34, s34, s90
    s_and_b32 s35, s2, 7
    s_lshl_b32 s35, s35, 8
    s_and_b32 s36, s2, 0xf8
    s_add_u32 s35, s35, s36
    s_add_u32 s35, s35, 22611968
    v_mov_b32 v8, s35
    v_mov_b32 v10, s34
    v_mov_b32 v11, s91
    s_mov_b64 exec, 1
    global_store_dwordx2 v8, v[10:11], s[88:89] sc1
    s_mov_b64 exec, -1
L_pub_vv:
L_h2_vv:
    v_mfma_f32_16x16x32_bf16 v[148:151], v[68:71], v[84:87], v[148:151]
    v_mfma_f32_16x16x32_bf16 v[144:147], v[68:71], v[80:83], v[144:147]
    s_add_u32 s21, s21, 1
    s_cmp_lg_u32 s21, 8
    s_cbranch_scc1 L_p1_vv
    s_waitcnt lgkmcnt(4)
    v_mfma_f32_16x16x32_bf16 v[88:91], v[24:27], v[40:43], v[88:91]
    ds_read_b128 v[56:59], v3 offset:0
    v_mfma_f32_16x16x32_bf16 v[92:95], v[24:27], v[44:47], v[92:95]
    ds_read_b64_tr_b16 v[72:73], v4 offset:8192
    v_mfma_f32_16x16x32_bf16 v[108:111], v[28:31], v[44:47], v[108:111]
    ds_read_b64_tr_b16 v[74:75], v4 offset:9216
    v_mfma_f32_16x16x32_bf16 v[104:107], v[28:31], v[40:43], v[104:107]
    ds_read_b64_tr_b16 v[76:77], v5 offset:8192
    ds_read_b64_tr_b16 v[78:79], v5 offset:9216
    v_mfma_f32_16x16x32_bf16 v[120:123], v[32:35], v[40:43], v[120:123]
    ds_read_b128 v[60:63], v2 offset:2048
    v_mfma_f32_16x16x32_bf16 v[124:127], v[32:35], v[44:47], v[124:127]
    ds_read_b128 v[64:67], v3 offset:4096
    v_mfma_f32_16x16x32_bf16 v[140:143], v[36:39], v[44:47], v[140:143]
    ds_read_b128 v[68:71], v2 offset:6144
    v_mfma_f32_16x16x32_bf16 v[136:139], v[36:39], v[40:43], v[136:139]
    ds_read_b64_tr_b16 v[80:81], v6 offset:8192
    ds_read_b64_tr_b16 v[82:83], v6 offset:9216
    s_waitcnt lgkmcnt(10)
    v_mfma_f32_16x16x32_bf16 v[96:99], v[24:27], v[48:51], v[96:99]
    ds_read_b64_tr_b16 v[84:85], v7 offset:8192
    ds_read_b64_tr_b16 v[86:87], v7 offset:9216
    s_mov_b32 s85, s84
    s_add_u32 s84, s84, 49152
    s_cmp_eq_u32 s84, 147456
    s_cselect_b32 s84, 0, s84
    s_sub_u32 s86, s84, s85
    v_add_u32 v2, s86, v2
    v_mfma_f32_16x16x32_bf16 v[100:103], v[24:27], v[52:55], v[100:103]
    v_add_u32 v3, s86, v3
    v_add_u32 v4, s86, v4
    v_add_u32 v5, s86, v5
    v_add_u32 v6, s86, v6
    v_add_u32 v7, s86, v7
    v_mfma_f32_16x16x32_bf16 v[116:119], v[28:31], v[52:55], v[116:119]
    v_and_b32 v249, 31, v1
    v_bfe_u32 v250, v249, 2, 1
    v_and_b32 v251, 3, v249
    v_lshrrev_b32 v252, 3, v249
    v_lshl_add_u32 v251, v252, 2, v251
    v_mfma_f32_16x16x32_bf16 v[112:115], v[28:31], v[48:51], v[112:115]
    v_mul_u32_u24 v250, 10, v250
    v_add_u32 v250, v250, v251
    v_add_u32 v252, 6, v250
    v_cmp_gt_u32 vcc, 4, v250
    v_lshlrev_b32 v242, 4, v1
    s_nop 0
    v_mfma_f32_16x16x32_bf16 v[128:131], v[32:35], v[48:51], v[128:131]
    v_cndmask_b32 v252, v252, v250, vcc
    v_cmp_lt_u32 vcc, 13, v250
    v_subrev_u32 v243, 10, v250
    s_nop 0
    v_cndmask_b32 v252, v252, v243, vcc
    v_mfma_f32_16x16x32_bf16 v[132:135], v[32:35], v[52:55], v[132:135]
    v_lshlrev_b32 v252, 4, v252
    v_lshrrev_b32 v243, 5, v1
    v_mul_u32_u24 v243, 320, v243
    v_add_u32 v243, v243, v252
    v_add_u32 v243, 5120, v243
    v_mfma_f32_16x16x32_bf16 v[148:151], v[36:39], v[52:55], v[148:151]
    v_cmp_eq_u32 vcc, 10, v251
    v_mov_b32 v244, 0xdddddddd
    v_mov_b32 v252, 0x3f803f80
    v_cndmask_b32 v252, 0, v252, vcc
    v_lshlrev_b32 v248, 4, v249
    v_mfma_f32_16x16x32_bf16 v[144:147], v[36:39], v[48:51], v[144:147]
    v_mov_b32 v168, v252
    v_mov_b32 v169, v252
    v_mov_b64 v[170:171], v[168:169]
    v_mov_b64 v[172:173], v[168:169]
    v_mov_b64 v[174:175], v[168:169]
    v_mov_b64 v[176:177], v[168:169]
    s_waitcnt lgkmcnt(4)
    v_mfma_f32_16x16x32_bf16 v[88:91], v[56:59], v[72:75], v[88:91]
    v_mfma_f32_16x16x32_bf16 v[92:95], v[56:59], v[76:79], v[92:95]
    v_mfma_f32_16x16x32_bf16 v[108:111], v[60:63], v[76:79], v[108:111]
    v_mfma_f32_16x16x32_bf16 v[104:107], v[60:63], v[72:75], v[104:107]
    v_mfma_f32_16x16x32_bf16 v[120:123], v[64:67], v[72:75], v[120:123]
    v_mfma_f32_16x16x32_bf16 v[124:127], v[64:67], v[76:79], v[124:127]
    s_mov_b32 s87, s85
    s_waitcnt vmcnt(0) lgkmcnt(0)
    s_barrier
    v_mfma_f32_16x16x32_bf16 v[140:143], v[68:71], v[76:79], v[140:143]
    ds_read_b128 v[24:27], v2 offset:0
    ds_read_b64_tr_b16 v[40:41], v4 offset:0
    v_mfma_f32_16x16x32_bf16 v[136:139], v[68:71], v[72:75], v[136:139]
    ds_read_b64_tr_b16 v[42:43], v4 offset:1024
    ds_read_b64_tr_b16 v[44:45], v5 offset:0
    v_mfma_f32_16x16x32_bf16 v[96:99], v[56:59], v[80:83], v[96:99]
    ds_read_b64_tr_b16 v[46:47], v5 offset:1024
    ds_read_b128 v[28:31], v3 offset:2048
    v_mfma_f32_16x16x32_bf16 v[100:103], v[56:59], v[84:87], v[100:103]
    ds_read_b128 v[32:35], v2 offset:4096
    ds_read_b128 v[36:39], v3 offset:6144
    v_mfma_f32_16x16x32_bf16 v[116:119], v[60:63], v[84:87], v[116:119]
    ds_read_b64_tr_b16 v[48:49], v6 offset:0
    ds_read_b64_tr_b16 v[50:51], v6 offset:1024
    v_mfma_f32_16x16x32_bf16 v[112:115], v[60:63], v[80:83], v[112:115]
    ds_read_b64_tr_b16 v[52:53], v7 offset:0
    ds_read_b64_tr_b16 v[54:55], v7 offset:1024
    v_mfma_f32_16x16x32_bf16 v[128:131], v[64:67], v[80:83], v[128:131]
    s_and_b32 s35, s2, 7
    s_lshl_b32 s35, s35, 8
    s_add_u32 s35, s35, 22611968
    v_and_b32 v8, 31, v1
    v_lshl_add_u32 v8, v8, 3, s35
    global_load_dwordx2 v[166:167], v8, s[88:89] sc1
    v_lshlrev_b32 v9, 4, v1
    v_lshlrev_b32 v10, 3, v1
    global_load_dwordx4 v[232:235], v9, s[80:81]
    global_load_dwordx4 v[236:239], v9, s[80:81] offset:1024
    global_load_dwordx2 v[240:241], v10, s[80:81] offset:2048
    v_mov_b64 v[178:179], v[168:169]
    v_mov_b64 v[180:181], v[168:169]
    v_mov_b64 v[182:183], v[168:169]
    v_mov_b64 v[184:185], v[168:169]
    v_mov_b64 v[186:187], v[168:169]
    v_mov_b64 v[188:189], v[168:169]
    v_mov_b64 v[190:191], v[168:169]
    v_mfma_f32_16x16x32_bf16 v[132:135], v[64:67], v[84:87], v[132:135]
    v_mov_b64 v[192:193], v[168:169]
    v_mov_b64 v[194:195], v[168:169]
    v_mov_b64 v[196:197], v[168:169]
    v_mov_b64 v[198:199], v[168:169]
    v_mov_b64 v[200:201], 0
    v_mov_b64 v[202:203], 0
    v_mov_b64 v[204:205], 0
    v_mov_b64 v[206:207], 0
    v_mfma_f32_16x16x32_bf16 v[148:151], v[68:71], v[84:87], v[148:151]
    v_mov_b64 v[208:209], 0
    v_mov_b64 v[210:211], 0
    v_mov_b64 v[212:213], 0
    v_mov_b64 v[214:215], 0
    v_mov_b64 v[216:217], 0
    v_mov_b64 v[218:219], 0
    v_mov_b64 v[220:221], 0
    v_mov_b64 v[222:223], 0
    v_mfma_f32_16x16x32_bf16 v[144:147], v[68:71], v[80:83], v[144:147]
    v_mov_b64 v[224:225], 0
    v_mov_b64 v[226:227], 0
    v_mov_b64 v[228:229], 0
    v_mov_b64 v[230:231], 0
    v_mov_b32 v246, v242
    v_mov_b32 v247, v243
    v_lshrrev_b32 v254, 5, v1
    v_lshl_add_u32 v254, v254, 3, v248
    v_mov_b32 v253, v248
    s_waitcnt lgkmcnt(4)
    v_mfma_f32_16x16x32_bf16 v[88:91], v[24:27], v[40:43], v[88:91]
    ds_read_b128 v[56:59], v3 offset:0
    v_mfma_f32_16x16x32_bf16 v[92:95], v[24:27], v[44:47], v[92:95]
    ds_read_b64_tr_b16 v[72:73], v4 offset:8192
    v_mfma_f32_16x16x32_bf16 v[108:111], v[28:31], v[44:47], v[108:111]
    ds_read_b64_tr_b16 v[74:75], v4 offset:9216
    v_mfma_f32_16x16x32_bf16 v[104:107], v[28:31], v[40:43], v[104:107]
    ds_read_b64_tr_b16 v[76:77], v5 offset:8192
    ds_read_b64_tr_b16 v[78:79], v5 offset:9216
    v_mfma_f32_16x16x32_bf16 v[120:123], v[32:35], v[40:43], v[120:123]
    ds_read_b128 v[60:63], v2 offset:2048
    v_mfma_f32_16x16x32_bf16 v[124:127], v[32:35], v[44:47], v[124:127]
    ds_read_b128 v[64:67], v3 offset:4096
    v_mfma_f32_16x16x32_bf16 v[140:143], v[36:39], v[44:47], v[140:143]
    ds_read_b128 v[68:71], v2 offset:6144
    v_mfma_f32_16x16x32_bf16 v[136:139], v[36:39], v[40:43], v[136:139]
    ds_read_b64_tr_b16 v[80:81], v6 offset:8192
    ds_read_b64_tr_b16 v[82:83], v6 offset:9216
    s_waitcnt lgkmcnt(10)
    v_mfma_f32_16x16x32_bf16 v[96:99], v[24:27], v[48:51], v[96:99]
    v_mfma_f32_16x16x32_bf16 v[100:103], v[24:27], v[52:55], v[100:103]
    ds_read_b64_tr_b16 v[84:85], v7 offset:8192
    v_mfma_f32_16x16x32_bf16 v[116:119], v[28:31], v[52:55], v[116:119]
    v_mfma_f32_16x16x32_bf16 v[112:115], v[28:31], v[48:51], v[112:115]
    ds_read_b64_tr_b16 v[86:87], v7 offset:9216
    s_waitcnt lgkmcnt(0)
    v_mfma_f32_16x16x32_bf16 v[88:91], v[56:59], v[72:75], v[88:91]
    v_mfma_f32_16x16x32_bf16 v[92:95], v[56:59], v[76:79], v[92:95]
    v_mfma_f32_16x16x32_bf16 v[108:111], v[60:63], v[76:79], v[108:111]
    v_mfma_f32_16x16x32_bf16 v[104:107], v[60:63], v[72:75], v[104:107]
    v_mfma_f32_16x16x32_bf16 v[120:123], v[64:67], v[72:75], v[120:123]
    v_mfma_f32_16x16x32_bf16 v[124:127], v[64:67], v[76:79], v[124:127]
    v_mfma_f32_16x16x32_bf16 v[140:143], v[68:71], v[76:79], v[140:143]
    v_mfma_f32_16x16x32_bf16 v[136:139], v[68:71], v[72:75], v[136:139]
    v_mfma_f32_16x16x32_bf16 v[128:131], v[32:35], v[48:51], v[128:131]
    v_mfma_f32_16x16x32_bf16 v[132:135], v[32:35], v[52:55], v[132:135]
    s_waitcnt vmcnt(0)
    s_getreg_b32 s63, hwreg(HW_REG_XCC_ID, 0, 4)
    s_xor_b32 s42, s90, s63
    v_mfma_f32_16x16x32_bf16 v[148:151], v[36:39], v[52:55], v[148:151]
    s_mov_b32 s43, s91
    v_cmp_eq_u64 vcc, s[42:43], v[166:167]
    s_cmp_lg_u32 s90, 0
    v_mfma_f32_16x16x32_bf16 v[144:147], v[36:39], v[48:51], v[144:147]
    s_cselect_b32 s63, 1, 0
    s_cmp_eq_u64 vcc, -1
    s_cselect_b32 s63, s63, 0
    v_mfma_f32_16x16x32_bf16 v[96:99], v[56:59], v[80:83], v[96:99]
    s_mov_b32 s57, s63
    s_cmp_lg_u32 s57, 0
    v_cvt_pk_bf16_f32 v88, v88, v89
    v_mfma_f32_16x16x32_bf16 v[100:103], v[56:59], v[84:87], v[100:103]
    v_cvt_pk_bf16_f32 v89, v90, v91
    v_cvt_pk_bf16_f32 v90, v104, v105
    v_cvt_pk_bf16_f32 v91, v106, v107
    v_mfma_f32_16x16x32_bf16 v[116:119], v[60:63], v[84:87], v[116:119]
    s_cbranch_scc1 L_v0_4p
    buffer_store_dwordx4 v[88:91], v152, s[16:19], s56 offen offset:0 sc1
    s_branch L_v0_4d
L_v0_4p:
    buffer_store_dwordx4 v[88:91], v152, s[16:19], s56 offen offset:0
L_v0_4d:
    v_cvt_pk_bf16_f32 v120, v120, v121
    v_cvt_pk_bf16_f32 v121, v122, v123
    v_mfma_f32_16x16x32_bf16 v[112:115], v[60:63], v[80:83], v[112:115]
    v_cvt_pk_bf16_f32 v122, v136, v137
    v_cvt_pk_bf16_f32 v123, v138, v139
    s_cbranch_scc1 L_v0_9p
    buffer_store_dwordx4 v[120:123], v152, s[16:19], s56 offen offset:1280 sc1
    s_branch L_v0_9d
L_v0_9p:
    buffer_store_dwordx4 v[120:123], v152, s[16:19], s56 offen offset:1280
L_v0_9d:
    v_mfma_f32_16x16x32_bf16 v[128:131], v[64:67], v[80:83], v[128:131]
    v_cvt_pk_bf16_f32 v92, v92, v93
    v_cvt_pk_bf16_f32 v93, v94, v95
    v_cvt_pk_bf16_f32 v94, v108, v109
    v_mfma_f32_16x16x32_bf16 v[132:135], v[64:67], v[84:87], v[132:135]
    v_cvt_pk_bf16_f32 v95, v110, v111
    s_cbranch_scc1 L_v0_14p
    buffer_store_dwordx4 v[92:95], v153, s[16:19], s56 offen offset:0 sc1
    s_branch L_v0_14d
L_v0_14p:
    buffer_store_dwordx4 v[92:95], v153, s[16:19], s56 offen offset:0
L_v0_14d:
    v_cvt_pk_bf16_f32 v124, v124, v125
    v_mfma_f32_16x16x32_bf16 v[148:151], v[68:71], v[84:87], v[148:151]
    v_cvt_pk_bf16_f32 v125, v126, v127
    v_cvt_pk_bf16_f32 v126, v140, v141
    v_cvt_pk_bf16_f32 v127, v142, v143
    s_cbranch_scc1 L_v0_19p
    buffer_store_dwordx4 v[124:127], v153, s[16:19], s56 offen offset:1280 sc1
    s_branch L_v0_19d
L_v0_19p:
    buffer_store_dwordx4 v[124:127], v153, s[16:19], s56 offen offset:1280
L_v0_19d:
    v_mfma_f32_16x16x32_bf16 v[144:147], v[68:71], v[80:83], v[144:147]
    s_nop 7
    s_cmp_lg_u32 s57, 0
    v_cvt_pk_bf16_f32 v96, v96, v97
    v_cvt_pk_bf16_f32 v97, v98, v99
    v_cvt_pk_bf16_f32 v98, v112, v113
    v_cvt_pk_bf16_f32 v99, v114, v115
    s_cbranch_scc1 L_v1_4p
    buffer_store_dwordx4 v[96:99], v154, s[16:19], s56 offen offset:0 sc1
    s_branch L_v1_4d
L_v1_4p:
    buffer_store_dwordx4 v[96:99], v154, s[16:19], s56 offen offset:0
L_v1_4d:
    v_cvt_pk_bf16_f32 v128, v128, v129
    v_cvt_pk_bf16_f32 v129, v130, v131
    v_cvt_pk_bf16_f32 v130, v144, v145
    v_cvt_pk_bf16_f32 v131, v146, v147
    s_cbranch_scc1 L_v1_9p
    buffer_store_dwordx4 v[128:131], v154, s[16:19], s56 offen offset:1280 sc1
    s_branch L_v1_9d
L_v1_9p:
    buffer_store_dwordx4 v[128:131], v154, s[16:19], s56 offen offset:1280
L_v1_9d:
    v_cvt_pk_bf16_f32 v100, v100, v101
    v_cvt_pk_bf16_f32 v101, v102, v103
    v_cvt_pk_bf16_f32 v102, v116, v117
    v_cvt_pk_bf16_f32 v103, v118, v119
    s_cbranch_scc1 L_v1_14p
    buffer_store_dwordx4 v[100:103], v155, s[16:19], s56 offen offset:0 sc1
    s_branch L_v1_14d
L_v1_14p:
    buffer_store_dwordx4 v[100:103], v155, s[16:19], s56 offen offset:0
L_v1_14d:
    v_cvt_pk_bf16_f32 v132, v132, v133
    v_cvt_pk_bf16_f32 v133, v134, v135
    v_cvt_pk_bf16_f32 v134, v148, v149
    v_cvt_pk_bf16_f32 v135, v150, v151
    s_cbranch_scc1 L_v1_19p
    buffer_store_dwordx4 v[132:135], v155, s[16:19], s56 offen offset:1280 sc1
    s_branch L_v1_19d
L_v1_19p:
    buffer_store_dwordx4 v[132:135], v155, s[16:19], s56 offen offset:1280
L_v1_19d:
L_p1_done:
    s_and_b32 s26, s2, 7
    s_lshr_b32 s27, s2, 3
    s_lshr_b32 s28, s26, 2
    s_and_b32 s29, s26, 3
    s_lshl_b32 s29, s29, 3
    s_and_b32 s30, s27, 7
    s_add_u32 s29, s29, s30
    s_lshr_b32 s30, s27, 3
    s_lshl_b32 s31, s28, 5
    s_add_u32 s31, s31, s29
    s_mul_i32 s32, s31, 163840
    s_mul_i32 s33, s31, 81920
    s_add_u32 s33, s33, 10485760
    s_mul_i32 s34, s28, 2621440
    s_add_u32 s34, s34, 15728640
    s_mov_b32 s10, 163840
    s_mov_b32 s11, 0x20000
    s_mov_b32 s14, 81920
    s_mov_b32 s15, 0x20000
    s_mov_b32 s18, 2621440
    s_mov_b32 s19, 0x20000
    s_add_u32 s8, s88, s32
    s_addc_u32 s9, s89, 0
    s_add_u32 s12, s88, s33
    s_addc_u32 s13, s89, 0
    s_add_u32 s16, s88, s34
    s_addc_u32 s17, s89, 0
    s_mov_b32 s22, 0x33ffff
    s_mov_b32 s23, 0x33ffff
    s_lshl_b32 s35, s30, 2
    s_lshr_b32 s36, s94, 1
    s_add_u32 s35, s35, s36
    s_mul_i32 s35, s35, 5120
    s_and_b32 s36, s94, 1
    s_lshl_b32 s37, s36, 11
    s_add_u32 s37, s37, s35
    s_lshl_b32 s38, s36, 9
    s_add_u32 s38, s38, s35
    s_add_u32 s38, s38, 4096
    s_lshl_b32 s39, s94, 10
    s_mov_b32 m0, s39
    s_cmp_lg_u32 s94, 7
    s_cbranch_scc1 L_p1_nq
L_p1_nq:
    s_waitcnt vmcnt(0)
    s_barrier
    s_mov_b32 s95, 1048576
L_non_a:
    v_readfirstlane_b32 s90, v160
    v_readfirstlane_b32 s91, v161
    s_sub_u32 s95, s95, 1
    s_nop 2
    s_cmp_lg_u32 s90, 0
    s_cbranch_scc1 L_nond_a
    s_cmp_eq_u32 s95, 0
    s_cbranch_scc1 L_nond_a
    v_mov_b32 v8, 0
    s_sleep 1
    global_load_dwordx2 v[160:161], v8, s[92:93] sc1
    s_waitcnt vmcnt(0)
    s_branch L_non_a
L_nond_a:
    s_cmp_lg_u32 s94, 0
    s_cbranch_scc1 L_p1_ns
    v_mov_b32 v8, s62
    v_mov_b32 v10, s90
    v_mov_b32 v11, s91
    s_mov_b64 exec, 1
    s_cmp_lg_u32 s57, 0
    s_cbranch_scc1 L_sig_1
    global_store_dwordx2 v8, v[10:11], s[88:89] sc1
    s_branch L_sigd_1
L_sig_1:
    global_store_dwordx2 v8, v[10:11], s[88:89]
L_sigd_1:
    s_mov_b64 exec, -1
L_p1_ns:
    s_cmp_lg_u32 s94, 7
    s_cbranch_scc1 L_p2_np
    s_mov_b32 s95, 1048576
L_poll_1:
    global_load_dwordx2 v[164:165], v245, s[88:89] sc1
    s_waitcnt vmcnt(0)
L_pollc_1:
    v_cmp_eq_u64 vcc, s[90:91], v[164:165]
    s_sub_u32 s95, s95, 1
    s_cmp_eq_u64 vcc, -1
    s_cbranch_scc1 L_polled_1
    s_sleep 1
    s_cmp_lg_u32 s95, 0
    s_cbranch_scc1 L_poll_1
L_polled_1:
L_p2_np:
    s_barrier
    buffer_load_dwordx4 v242, s[8:11], s39 offen sc1 lds
    s_add_u32 s39, s39, 8192
    s_mov_b32 m0, s39
    buffer_load_dwordx4 v[16:19], v242, s[12:15], s37 offen sc1
    buffer_load_dwordx2 v[24:25], v254, s[12:15], s38 offen sc1
    buffer_load_dwordx4 v[20:23], v242, s[12:15], s37 offen offset:1024 sc1
    s_waitcnt vmcnt(3)
    s_barrier
    ds_read_b128 v[48:51], v253 offset:4096
    ds_read_b128 v[32:35], v242 offset:0
    ds_read_b128 v[36:39], v242 offset:1024
    ds_read_b128 v[40:43], v242 offset:2048
    ds_read_b128 v[44:47], v242 offset:3072
    ds_read_b128 v[52:55], v253 offset:4608
    s_mov_b64 exec, s[22:23]
    ds_read_b128 v[168:171], v243 offset:0
    ds_read_b128 v[172:175], v243 offset:640
    ds_read_b128 v[176:179], v243 offset:1280
    ds_read_b128 v[180:183], v243 offset:1920
    s_mov_b64 exec, -1
    s_mov_b32 s21, 0
    buffer_load_dwordx4 v242, s[8:11], s39 offen sc1 lds
    s_add_u32 s39, s39, 8192
    s_mov_b32 m0, s39
    s_nop 0
    buffer_load_dwordx4 v242, s[8:11], s39 offen sc1 lds
    s_add_u32 s39, s39, 8192
    s_mov_b32 m0, s39
    s_nop 0
    buffer_load_dwordx4 v242, s[8:11], s39 offen sc1 lds
    s_add_u32 s39, s39, 8192
    s_mov_b32 m0, s39
    s_nop 0
    s_waitcnt vmcnt(4) lgkmcnt(9)
    v_mfma_f32_32x32x4_2b_bf16 v[56:87], v[48:49], v[24:25], 0
    s_nop 15
    s_waitcnt lgkmcnt(8)
    s_nop 0
    v_mfma_f32_32x32x16_bf16 v[56:71], v[32:35], v[16:19], v[56:71]
    s_waitcnt vmcnt(3)
    s_nop 7
    s_nop 2
    v_mfma_f32_32x32x16_bf16 v[72:87], v[32:35], v[20:23], v[72:87]
    s_setprio 1
    v_exp_f32 v56, v56
    v_exp_f32 v57, v57
    v_exp_f32 v58, v58
    v_exp_f32 v59, v59
    v_mfma_f32_32x32x4_2b_bf16 v[88:119], v[50:51], v[24:25], 0
    buffer_load_dwordx4 v242, s[8:11], s39 offen sc1 lds
    s_add_u32 s39, s39, 8192
    s_mov_b32 m0, s39
    s_nop 0
    buffer_load_dwordx4 v242, s[8:11], s39 offen sc1 lds
    s_add_u32 s39, s39, 8192
    s_mov_b32 m0, s39
    v_exp_f32 v60, v60
    v_exp_f32 v61, v61
    v_exp_f32 v62, v62
    v_exp_f32 v63, v63
    v_exp_f32 v64, v64
    v_exp_f32 v65, v65
    v_exp_f32 v66, v66
    v_exp_f32 v67, v67
    s_nop 0
    v_exp_f32 v68, v68
    v_exp_f32 v69, v69
    v_exp_f32 v70, v70
    v_exp_f32 v71, v71
    s_waitcnt lgkmcnt(2)
    s_nop 0
    v_exp_f32 v72, v72
    v_exp_f32 v73, v73
    v_exp_f32 v74, v74
    v_exp_f32 v75, v75
    v_mfma_f32_32x32x16_bf16 v[88:103], v[36:39], v[16:19], v[88:103]
    buffer_load_dwordx4 v242, s[8:11], s39 offen sc1 lds
    s_add_u32 s39, s39, 8192
    s_mov_b32 m0, s39
    v_exp_f32 v76, v76
    v_exp_f32 v77, v77
    v_exp_f32 v78, v78
    v_exp_f32 v79, v79
    v_smfmac_f32_32x32x32_bf16 v[200:215], v[168:171], v[56:63], v244
    v_exp_f32 v80, v80
    v_exp_f32 v81, v81
    v_exp_f32 v82, v82
    v_exp_f32 v83, v83
    v_smfmac_f32_32x32x32_bf16 v[200:215], v[172:175], v[64:71], v244
    v_exp_f32 v84, v84
    v_exp_f32 v85, v85
    v_exp_f32 v86, v86
    v_exp_f32 v87, v87
    v_mfma_f32_32x32x16_bf16 v[104:119], v[36:39], v[20:23], v[104:119]
    v_exp_f32 v88, v88
    v_exp_f32 v89, v89
    v_exp_f32 v90, v90
    v_exp_f32 v91, v91
    v_mfma_f32_32x32x4_2b_bf16 v[120:151], v[52:53], v[24:25], 0
    buffer_load_dwordx4 v242, s[8:11], s39 offen sc1 lds
    s_add_u32 s39, s39, 8192
    s_mov_b32 m0, s39
    v_exp_f32 v92, v92
    v_exp_f32 v93, v93
    v_exp_f32 v94, v94
    v_exp_f32 v95, v95
    v_exp_f32 v96, v96
    v_exp_f32 v97, v97
    v_exp_f32 v98, v98
    v_exp_f32 v99, v99
    v_smfmac_f32_32x32x32_bf16 v[216:231], v[168:171], v[72:79], v244
    v_exp_f32 v100, v100
    v_exp_f32 v101, v101
    v_exp_f32 v102, v102
    v_exp_f32 v103, v103
    s_waitcnt vmcnt(4)
    s_barrier
    ds_read_b128 v[32:35], v246 offset:10240
    ds_read_b128 v[48:51], v253 offset:14336
    s_mov_b64 exec, s[22:23]
    ds_read_b128 v[184:187], v247 offset:2560
    ds_read_b128 v[188:191], v247 offset:3200
    ds_read_b128 v[192:195], v247 offset:3840
    ds_read_b128 v[196:199], v247 offset:4480
    s_mov_b64 exec, -1
    ds_read_b128 v[36:39], v246 offset:11264
    s_waitcnt lgkmcnt(7)
    v_smfmac_f32_32x32x32_bf16 v[216:231], v[172:175], v[80:87], v244
    s_mov_b64 exec, s[22:23]
    ds_read_b128 v[168:171], v247 offset:10240
    ds_read_b128 v[172:175], v247 offset:10880
    s_mov_b64 exec, -1
    v_exp_f32 v104, v104
    v_exp_f32 v105, v105
    v_exp_f32 v106, v106
    v_exp_f32 v107, v107
    v_mfma_f32_32x32x16_bf16 v[120:135], v[40:43], v[16:19], v[120:135]
    buffer_load_dwordx4 v242, s[8:11], s39 offen sc1 lds
    s_add_u32 s39, s39, 8192
    s_mov_b32 m0, s39
    s_nop 0
    buffer_load_dwordx4 v242, s[8:11], s39 offen sc1 lds
    s_add_u32 s39, s39, 8192
    s_mov_b32 m0, s39
    v_exp_f32 v108, v108
    v_exp_f32 v109, v109
    v_exp_f32 v110, v110
    v_exp_f32 v111, v111
    v_smfmac_f32_32x32x32_bf16 v[200:215], v[176:179], v[88:95], v244
    v_exp_f32 v112, v112
    v_exp_f32 v113, v113
    v_exp_f32 v114, v114
    v_exp_f32 v115, v115
    v_smfmac_f32_32x32x32_bf16 v[200:215], v[180:183], v[96:103], v244
    v_exp_f32 v116, v116
    v_exp_f32 v117, v117
    v_exp_f32 v118, v118
    v_exp_f32 v119, v119
    v_mfma_f32_32x32x16_bf16 v[136:151], v[40:43], v[20:23], v[136:151]
    ds_read_b128 v[40:43], v246 offset:12288
    v_exp_f32 v120, v120
    v_exp_f32 v121, v121
    v_exp_f32 v122, v122
    v_exp_f32 v123, v123
    v_mfma_f32_32x32x4_2b_bf16 v[56:87], v[54:55], v[24:25], 0
    ds_read_b128 v[52:55], v253 offset:14848
    buffer_load_dwordx4 v242, s[8:11], s39 offen sc1 lds
    s_add_u32 s39, s39, 8192
    s_mov_b32 m0, s39
    v_exp_f32 v124, v124
    v_exp_f32 v125, v125
    v_exp_f32 v126, v126
    v_exp_f32 v127, v127
    v_exp_f32 v128, v128
    v_exp_f32 v129, v129
    v_exp_f32 v130, v130
    v_exp_f32 v131, v131
    v_smfmac_f32_32x32x32_bf16 v[216:231], v[176:179], v[104:111], v244
    v_exp_f32 v132, v132
    v_exp_f32 v133, v133
    v_exp_f32 v134, v134
    v_exp_f32 v135, v135
    s_waitcnt lgkmcnt(7)
    v_smfmac_f32_32x32x32_bf16 v[216:231], v[180:183], v[112:119], v244
    s_mov_b64 exec, s[22:23]
    ds_read_b128 v[176:179], v247 offset:11520
    ds_read_b128 v[180:183], v247 offset:12160
    s_mov_b64 exec, -1
    v_exp_f32 v136, v136
    v_exp_f32 v137, v137
    v_exp_f32 v138, v138
    v_exp_f32 v139, v139
    v_mfma_f32_32x32x16_bf16 v[56:71], v[44:47], v[16:19], v[56:71]
    buffer_load_dwordx4 v242, s[8:11], s39 offen sc1 lds
    s_add_u32 s39, s39, 8192
    s_mov_b32 m0, s39
    v_exp_f32 v140, v140
    v_exp_f32 v141, v141
    v_exp_f32 v142, v142
    v_exp_f32 v143, v143
    v_smfmac_f32_32x32x32_bf16 v[200:215], v[184:187], v[120:127], v244
    v_exp_f32 v144, v144
    v_exp_f32 v145, v145
    v_exp_f32 v146, v146
    v_exp_f32 v147, v147
    v_smfmac_f32_32x32x32_bf16 v[200:215], v[188:191], v[128:135], v244
    v_exp_f32 v148, v148
    v_exp_f32 v149, v149
    v_exp_f32 v150, v150
    v_exp_f32 v151, v151
    v_mfma_f32_32x32x16_bf16 v[72:87], v[44:47], v[20:23], v[72:87]
    ds_read_b128 v[44:47], v246 offset:13312
    s_setprio 0
    v_exp_f32 v56, v56
    v_exp_f32 v57, v57
    v_exp_f32 v58, v58
    v_exp_f32 v59, v59
    v_mfma_f32_32x32x4_2b_bf16 v[88:119], v[48:49], v[24:25], 0
    buffer_load_dwordx4 v242, s[8:11], s39 offen sc1 lds
    s_add_u32 s39, s39, 8192
    s_mov_b32 m0, s39
    s_nop 0
    buffer_load_dwordx4 v242, s[8:11], s39 offen sc1 lds
    s_add_u32 s39, s39, 8192
    s_mov_b32 m0, s39
    v_exp_f32 v60, v60
    v_exp_f32 v61, v61
    v_exp_f32 v62, v62
    v_exp_f32 v63, v63
    v_exp_f32 v64, v64
    v_exp_f32 v65, v65
    v_exp_f32 v66, v66
    v_exp_f32 v67, v67
    v_smfmac_f32_32x32x32_bf16 v[216:231], v[184:187], v[136:143], v244
    v_exp_f32 v68, v68
    v_exp_f32 v69, v69
    v_exp_f32 v70, v70
    v_exp_f32 v71, v71
    s_waitcnt lgkmcnt(8)
    v_smfmac_f32_32x32x32_bf16 v[216:231], v[188:191], v[144:151], v244
    s_mov_b64 exec, s[22:23]
    ds_read_b128 v[184:187], v247 offset:12800
    ds_read_b128 v[188:191], v247 offset:13440
    s_mov_b64 exec, -1
    v_exp_f32 v72, v72
    v_exp_f32 v73, v73
    v_exp_f32 v74, v74
    v_exp_f32 v75, v75
    v_mfma_f32_32x32x16_bf16 v[88:103], v[32:35], v[16:19], v[88:103]
    buffer_load_dwordx4 v242, s[8:11], s39 offen sc1 lds
    s_add_u32 s39, s39, 8192
    s_mov_b32 m0, s39
    v_exp_f32 v76, v76
    v_exp_f32 v77, v77
    v_exp_f32 v78, v78
    v_exp_f32 v79, v79
    v_smfmac_f32_32x32x32_bf16 v[200:215], v[192:195], v[56:63], v244
    v_exp_f32 v80, v80
    v_exp_f32 v81, v81
    v_exp_f32 v82, v82
    v_exp_f32 v83, v83
    v_smfmac_f32_32x32x32_bf16 v[200:215], v[196:199], v[64:71], v244
    v_exp_f32 v84, v84
    v_exp_f32 v85, v85
    v_exp_f32 v86, v86
    v_exp_f32 v87, v87
    v_mfma_f32_32x32x16_bf16 v[104:119], v[32:35], v[20:23], v[104:119]
    ds_read_b128 v[32:35], v246 offset:20480
    s_setprio 1
    v_exp_f32 v88, v88
    v_exp_f32 v89, v89
    v_exp_f32 v90, v90
    v_exp_f32 v91, v91
    v_mfma_f32_32x32x4_2b_bf16 v[120:151], v[50:51], v[24:25], 0
    ds_read_b128 v[48:51], v253 offset:24576
    buffer_load_dwordx4 v242, s[8:11], s39 offen sc1 lds
    s_add_u32 s39, s39, 8192
    s_mov_b32 m0, s39
    v_exp_f32 v92, v92
    v_exp_f32 v93, v93
    v_exp_f32 v94, v94
    v_exp_f32 v95, v95
    v_exp_f32 v96, v96
    v_exp_f32 v97, v97
    v_exp_f32 v98, v98
    v_exp_f32 v99, v99
    v_smfmac_f32_32x32x32_bf16 v[216:231], v[192:195], v[72:79], v244
    v_exp_f32 v100, v100
    v_exp_f32 v101, v101
    v_exp_f32 v102, v102
    v_exp_f32 v103, v103
    s_waitcnt lgkmcnt(9)
    v_smfmac_f32_32x32x32_bf16 v[216:231], v[196:199], v[80:87], v244
    s_mov_b64 exec, s[22:23]
    ds_read_b128 v[192:195], v247 offset:14080
    ds_read_b128 v[196:199], v247 offset:14720
    s_mov_b64 exec, -1
    v_exp_f32 v104, v104
    v_exp_f32 v105, v105
    v_exp_f32 v106, v106
    v_exp_f32 v107, v107
    v_mfma_f32_32x32x16_bf16 v[120:135], v[36:39], v[16:19], v[120:135]
    buffer_load_dwordx4 v242, s[8:11], s39 offen sc1 lds
    s_add_u32 s39, s39, 8192
    s_mov_b32 m0, s39
    s_nop 0
    buffer_load_dwordx4 v242, s[8:11], s39 offen sc1 lds
    s_add_u32 s39, s39, 8192
    s_mov_b32 m0, s39
    v_exp_f32 v108, v108
    v_exp_f32 v109, v109
    v_exp_f32 v110, v110
    v_exp_f32 v111, v111
    v_smfmac_f32_32x32x32_bf16 v[200:215], v[168:171], v[88:95], v244
    v_exp_f32 v112, v112
    v_exp_f32 v113, v113
    v_exp_f32 v114, v114
    v_exp_f32 v115, v115
    v_smfmac_f32_32x32x32_bf16 v[200:215], v[172:175], v[96:103], v244
    v_exp_f32 v116, v116
    v_exp_f32 v117, v117
    v_exp_f32 v118, v118
    v_exp_f32 v119, v119
    s_waitcnt lgkmcnt(9)
    v_mfma_f32_32x32x16_bf16 v[136:151], v[36:39], v[20:23], v[136:151]
    ds_read_b128 v[36:39], v246 offset:21504
    v_exp_f32 v120, v120
    v_exp_f32 v121, v121
    v_exp_f32 v122, v122
    v_exp_f32 v123, v123
    v_mfma_f32_32x32x4_2b_bf16 v[56:87], v[52:53], v[24:25], 0
    buffer_load_dwordx4 v242, s[8:11], s39 offen sc1 lds
    s_add_u32 s39, s39, 8192
    s_mov_b32 m0, s39
    v_exp_f32 v124, v124
    v_exp_f32 v125, v125
    v_exp_f32 v126, v126
    v_exp_f32 v127, v127
    v_exp_f32 v128, v128
    v_exp_f32 v129, v129
    v_exp_f32 v130, v130
    v_exp_f32 v131, v131
    v_smfmac_f32_32x32x32_bf16 v[216:231], v[168:171], v[104:111], v244
    v_exp_f32 v132, v132
    v_exp_f32 v133, v133
    v_exp_f32 v134, v134
    v_exp_f32 v135, v135
    s_waitcnt lgkmcnt(8)
    v_smfmac_f32_32x32x32_bf16 v[216:231], v[172:175], v[112:119], v244
    s_mov_b64 exec, s[22:23]
    ds_read_b128 v[168:171], v247 offset:20480
    ds_read_b128 v[172:175], v247 offset:21120
    s_mov_b64 exec, -1
    v_exp_f32 v136, v136
    v_exp_f32 v137, v137
    v_exp_f32 v138, v138
    v_exp_f32 v139, v139
    v_mfma_f32_32x32x16_bf16 v[56:71], v[40:43], v[16:19], v[56:71]
    buffer_load_dwordx4 v242, s[8:11], s39 offen sc1 lds
    s_add_u32 s39, s39, 8192
    s_mov_b32 m0, s39
    v_exp_f32 v140, v140
    v_exp_f32 v141, v141
    v_exp_f32 v142, v142
    v_exp_f32 v143, v143
    v_smfmac_f32_32x32x32_bf16 v[200:215], v[176:179], v[120:127], v244
    v_exp_f32 v144, v144
    v_exp_f32 v145, v145
    v_exp_f32 v146, v146
    v_exp_f32 v147, v147
    v_smfmac_f32_32x32x32_bf16 v[200:215], v[180:183], v[128:135], v244
    v_exp_f32 v148, v148
    v_exp_f32 v149, v149
    v_exp_f32 v150, v150
    v_exp_f32 v151, v151
    v_mfma_f32_32x32x16_bf16 v[72:87], v[40:43], v[20:23], v[72:87]
    ds_read_b128 v[40:43], v246 offset:22528
    v_exp_f32 v56, v56
    v_exp_f32 v57, v57
    v_exp_f32 v58, v58
    v_exp_f32 v59, v59
    v_mfma_f32_32x32x4_2b_bf16 v[88:119], v[54:55], v[24:25], 0
    ds_read_b128 v[52:55], v253 offset:25088
    v_exp_f32 v60, v60
    v_exp_f32 v61, v61
    v_exp_f32 v62, v62
    v_exp_f32 v63, v63
    v_exp_f32 v64, v64
    v_exp_f32 v65, v65
    v_exp_f32 v66, v66
    v_exp_f32 v67, v67
    v_smfmac_f32_32x32x32_bf16 v[216:231], v[176:179], v[136:143], v244
    v_exp_f32 v68, v68
    v_exp_f32 v69, v69
    v_exp_f32 v70, v70
    v_exp_f32 v71, v71
    s_waitcnt lgkmcnt(9)
    v_smfmac_f32_32x32x32_bf16 v[216:231], v[180:183], v[144:151], v244
    s_mov_b64 exec, s[22:23]
    ds_read_b128 v[176:179], v247 offset:21760
    ds_read_b128 v[180:183], v247 offset:22400
    s_mov_b64 exec, -1
    v_exp_f32 v72, v72
    v_exp_f32 v73, v73
    v_exp_f32 v74, v74
    v_exp_f32 v75, v75
    v_mfma_f32_32x32x16_bf16 v[88:103], v[44:47], v[16:19], v[88:103]
    v_exp_f32 v76, v76
    v_exp_f32 v77, v77
    v_exp_f32 v78, v78
    v_exp_f32 v79, v79
    v_smfmac_f32_32x32x32_bf16 v[200:215], v[184:187], v[56:63], v244
    v_exp_f32 v80, v80
    v_exp_f32 v81, v81
    v_exp_f32 v82, v82
    v_exp_f32 v83, v83
    v_smfmac_f32_32x32x32_bf16 v[200:215], v[188:191], v[64:71], v244
    v_exp_f32 v84, v84
    v_exp_f32 v85, v85
    v_exp_f32 v86, v86
    v_exp_f32 v87, v87
    s_waitcnt lgkmcnt(9)
    v_mfma_f32_32x32x16_bf16 v[104:119], v[44:47], v[20:23], v[104:119]
    ds_read_b128 v[44:47], v246 offset:23552
    s_setprio 0
    v_exp_f32 v88, v88
    v_exp_f32 v89, v89
    v_exp_f32 v90, v90
    v_exp_f32 v91, v91
    v_mfma_f32_32x32x4_2b_bf16 v[120:151], v[48:49], v[24:25], 0
    v_exp_f32 v92, v92
    v_exp_f32 v93, v93
    v_exp_f32 v94, v94
    v_exp_f32 v95, v95
    v_exp_f32 v96, v96
    v_exp_f32 v97, v97
    v_exp_f32 v98, v98
    v_exp_f32 v99, v99
    v_smfmac_f32_32x32x32_bf16 v[216:231], v[184:187], v[72:79], v244
    v_exp_f32 v100, v100
    v_exp_f32 v101, v101
    v_exp_f32 v102, v102
    v_exp_f32 v103, v103
    s_waitcnt lgkmcnt(8)
    v_smfmac_f32_32x32x32_bf16 v[216:231], v[188:191], v[80:87], v244
    s_mov_b64 exec, s[22:23]
    ds_read_b128 v[184:187], v247 offset:23040
    ds_read_b128 v[188:191], v247 offset:23680
    s_mov_b64 exec, -1
    v_exp_f32 v104, v104
    v_exp_f32 v105, v105
    v_exp_f32 v106, v106
    v_exp_f32 v107, v107
    v_mfma_f32_32x32x16_bf16 v[120:135], v[32:35], v[16:19], v[120:135]
    v_exp_f32 v108, v108
    v_exp_f32 v109, v109
    v_exp_f32 v110, v110
    v_exp_f32 v111, v111
    v_smfmac_f32_32x32x32_bf16 v[200:215], v[192:195], v[88:95], v244
    v_exp_f32 v112, v112
    v_exp_f32 v113, v113
    v_exp_f32 v114, v114
    v_exp_f32 v115, v115
    v_smfmac_f32_32x32x32_bf16 v[200:215], v[196:199], v[96:103], v244
    v_exp_f32 v116, v116
    v_exp_f32 v117, v117
    v_exp_f32 v118, v118
    v_exp_f32 v119, v119
    v_add_u32 v246, 20480, v246
    v_add_u32 v247, 20480, v247
    v_add_u32 v253, 20480, v253
    s_waitcnt vmcnt(0)
    s_barrier
.p2align 5
L_p2_loop:
    v_mfma_f32_32x32x16_bf16 v[136:151], v[32:35], v[20:23], v[136:151]
    ds_read_b128 v[32:35], v246 offset:10240
    s_setprio 1
    v_exp_f32 v120, v120
    v_exp_f32 v121, v121
    v_exp_f32 v122, v122
    v_exp_f32 v123, v123
    v_mfma_f32_32x32x4_2b_bf16 v[56:87], v[50:51], v[24:25], 0
    ds_read_b128 v[48:51], v253 offset:14336
    v_exp_f32 v124, v124
    v_exp_f32 v125, v125
    v_exp_f32 v126, v126
    v_exp_f32 v127, v127
    v_exp_f32 v128, v128
    v_exp_f32 v129, v129
    v_exp_f32 v130, v130
    v_exp_f32 v131, v131
    v_smfmac_f32_32x32x32_bf16 v[216:231], v[192:195], v[104:111], v244
    v_exp_f32 v132, v132
    v_exp_f32 v133, v133
    v_exp_f32 v134, v134
    v_exp_f32 v135, v135
    v_smfmac_f32_32x32x32_bf16 v[216:231], v[196:199], v[112:119], v244
    s_mov_b64 exec, s[22:23]
    ds_read_b128 v[192:195], v247 offset:3840
    ds_read_b128 v[196:199], v247 offset:4480
    s_mov_b64 exec, -1
    v_exp_f32 v136, v136
    v_exp_f32 v137, v137
    v_exp_f32 v138, v138
    v_exp_f32 v139, v139
    v_mfma_f32_32x32x16_bf16 v[56:71], v[36:39], v[16:19], v[56:71]
    v_exp_f32 v140, v140
    v_exp_f32 v141, v141
    v_exp_f32 v142, v142
    v_exp_f32 v143, v143
    v_smfmac_f32_32x32x32_bf16 v[200:215], v[168:171], v[120:127], v244
    v_exp_f32 v144, v144
    v_exp_f32 v145, v145
    v_exp_f32 v146, v146
    v_exp_f32 v147, v147
    v_smfmac_f32_32x32x32_bf16 v[200:215], v[172:175], v[128:135], v244
    v_exp_f32 v148, v148
    v_exp_f32 v149, v149
    v_exp_f32 v150, v150
    v_exp_f32 v151, v151
    v_mfma_f32_32x32x16_bf16 v[72:87], v[36:39], v[20:23], v[72:87]
    ds_read_b128 v[36:39], v246 offset:11264
    v_exp_f32 v56, v56
    v_exp_f32 v57, v57
    v_exp_f32 v58, v58
    v_exp_f32 v59, v59
    v_mfma_f32_32x32x4_2b_bf16 v[88:119], v[52:53], v[24:25], 0
    v_exp_f32 v60, v60
    v_exp_f32 v61, v61
    v_exp_f32 v62, v62
    v_exp_f32 v63, v63
    v_exp_f32 v64, v64
    v_exp_f32 v65, v65
    v_exp_f32 v66, v66
    v_exp_f32 v67, v67
    v_smfmac_f32_32x32x32_bf16 v[216:231], v[168:171], v[136:143], v244
    v_exp_f32 v68, v68
    v_exp_f32 v69, v69
    v_exp_f32 v70, v70
    v_exp_f32 v71, v71
    s_waitcnt lgkmcnt(3)
    v_smfmac_f32_32x32x32_bf16 v[216:231], v[172:175], v[144:151], v244
    s_mov_b64 exec, s[22:23]
    ds_read_b128 v[168:171], v247 offset:10240
    ds_read_b128 v[172:175], v247 offset:10880
    s_mov_b64 exec, -1
    v_exp_f32 v72, v72
    v_exp_f32 v73, v73
    v_exp_f32 v74, v74
    v_exp_f32 v75, v75
    v_mfma_f32_32x32x16_bf16 v[88:103], v[40:43], v[16:19], v[88:103]
    v_exp_f32 v76, v76
    v_exp_f32 v77, v77
    v_exp_f32 v78, v78
    v_exp_f32 v79, v79
    v_smfmac_f32_32x32x32_bf16 v[200:215], v[176:179], v[56:63], v244
    v_exp_f32 v80, v80
    v_exp_f32 v81, v81
    v_exp_f32 v82, v82
    v_exp_f32 v83, v83
    v_smfmac_f32_32x32x32_bf16 v[200:215], v[180:183], v[64:71], v244
    v_exp_f32 v84, v84
    v_exp_f32 v85, v85
    v_exp_f32 v86, v86
    v_exp_f32 v87, v87
    v_mfma_f32_32x32x16_bf16 v[104:119], v[40:43], v[20:23], v[104:119]
    ds_read_b128 v[40:43], v246 offset:12288
    v_exp_f32 v88, v88
    v_exp_f32 v89, v89
    v_exp_f32 v90, v90
    v_exp_f32 v91, v91
    v_mfma_f32_32x32x4_2b_bf16 v[120:151], v[54:55], v[24:25], 0
    ds_read_b128 v[52:55], v253 offset:14848
    v_exp_f32 v92, v92
    v_exp_f32 v93, v93
    v_exp_f32 v94, v94
    v_exp_f32 v95, v95
    v_exp_f32 v96, v96
    v_exp_f32 v97, v97
    v_exp_f32 v98, v98
    v_exp_f32 v99, v99
    v_smfmac_f32_32x32x32_bf16 v[216:231], v[176:179], v[72:79], v244
    v_exp_f32 v100, v100
    v_exp_f32 v101, v101
    v_exp_f32 v102, v102
    v_exp_f32 v103, v103
    v_smfmac_f32_32x32x32_bf16 v[216:231], v[180:183], v[80:87], v244
    s_mov_b64 exec, s[22:23]
    ds_read_b128 v[176:179], v247 offset:11520
    ds_read_b128 v[180:183], v247 offset:12160
    s_mov_b64 exec, -1
    v_exp_f32 v104, v104
    v_exp_f32 v105, v105
    v_exp_f32 v106, v106
    v_exp_f32 v107, v107
    v_mfma_f32_32x32x16_bf16 v[120:135], v[44:47], v[16:19], v[120:135]
    v_exp_f32 v108, v108
    v_exp_f32 v109, v109
    v_exp_f32 v110, v110
    v_exp_f32 v111, v111
    v_smfmac_f32_32x32x32_bf16 v[200:215], v[184:187], v[88:95], v244
    v_exp_f32 v112, v112
    v_exp_f32 v113, v113
    v_exp_f32 v114, v114
    v_exp_f32 v115, v115
    v_smfmac_f32_32x32x32_bf16 v[200:215], v[188:191], v[96:103], v244
    v_exp_f32 v116, v116
    v_exp_f32 v117, v117
    v_exp_f32 v118, v118
    v_exp_f32 v119, v119
    v_mfma_f32_32x32x16_bf16 v[136:151], v[44:47], v[20:23], v[136:151]
    ds_read_b128 v[44:47], v246 offset:13312
    v_exp_f32 v120, v120
    v_exp_f32 v121, v121
    v_exp_f32 v122, v122
    v_exp_f32 v123, v123
    v_mfma_f32_32x32x4_2b_bf16 v[56:87], v[48:49], v[24:25], 0
    v_exp_f32 v124, v124
    v_exp_f32 v125, v125
    v_exp_f32 v126, v126
    v_exp_f32 v127, v127
    v_exp_f32 v128, v128
    v_exp_f32 v129, v129
    v_exp_f32 v130, v130
    v_exp_f32 v131, v131
    v_smfmac_f32_32x32x32_bf16 v[216:231], v[184:187], v[104:111], v244
    v_exp_f32 v132, v132
    v_exp_f32 v133, v133
    v_exp_f32 v134, v134
    v_exp_f32 v135, v135
    s_waitcnt lgkmcnt(3)
    v_smfmac_f32_32x32x32_bf16 v[216:231], v[188:191], v[112:119], v244
    s_mov_b64 exec, s[22:23]
    ds_read_b128 v[184:187], v247 offset:12800
    ds_read_b128 v[188:191], v247 offset:13440
    s_mov_b64 exec, -1
    v_exp_f32 v136, v136
    v_exp_f32 v137, v137
    v_exp_f32 v138, v138
    v_exp_f32 v139, v139
    v_mfma_f32_32x32x16_bf16 v[56:71], v[32:35], v[16:19], v[56:71]
    v_exp_f32 v140, v140
    v_exp_f32 v141, v141
    v_exp_f32 v142, v142
    v_exp_f32 v143, v143
    v_smfmac_f32_32x32x32_bf16 v[200:215], v[192:195], v[120:127], v244
    v_exp_f32 v144, v144
    v_exp_f32 v145, v145
    v_exp_f32 v146, v146
    v_exp_f32 v147, v147
    v_smfmac_f32_32x32x32_bf16 v[200:215], v[196:199], v[128:135], v244
    v_exp_f32 v148, v148
    v_exp_f32 v149, v149
    v_exp_f32 v150, v150
    v_exp_f32 v151, v151
    v_mfma_f32_32x32x16_bf16 v[72:87], v[32:35], v[20:23], v[72:87]
    ds_read_b128 v[32:35], v246 offset:20480
    v_exp_f32 v56, v56
    v_exp_f32 v57, v57
    v_exp_f32 v58, v58
    v_exp_f32 v59, v59
    v_mfma_f32_32x32x4_2b_bf16 v[88:119], v[50:51], v[24:25], 0
    ds_read_b128 v[48:51], v253 offset:24576
    v_exp_f32 v60, v60
    v_exp_f32 v61, v61
    v_exp_f32 v62, v62
    v_exp_f32 v63, v63
    v_exp_f32 v64, v64
    v_exp_f32 v65, v65
    v_exp_f32 v66, v66
    v_exp_f32 v67, v67
    v_smfmac_f32_32x32x32_bf16 v[216:231], v[192:195], v[136:143], v244
    v_exp_f32 v68, v68
    v_exp_f32 v69, v69
    v_exp_f32 v70, v70
    v_exp_f32 v71, v71
    v_smfmac_f32_32x32x32_bf16 v[216:231], v[196:199], v[144:151], v244
    s_mov_b64 exec, s[22:23]
    ds_read_b128 v[192:195], v247 offset:14080
    ds_read_b128 v[196:199], v247 offset:14720
    s_mov_b64 exec, -1
    v_exp_f32 v72, v72
    v_exp_f32 v73, v73
    v_exp_f32 v74, v74
    v_exp_f32 v75, v75
    v_mfma_f32_32x32x16_bf16 v[88:103], v[36:39], v[16:19], v[88:103]
    v_exp_f32 v76, v76
    v_exp_f32 v77, v77
    v_exp_f32 v78, v78
    v_exp_f32 v79, v79
    v_smfmac_f32_32x32x32_bf16 v[200:215], v[168:171], v[56:63], v244
    v_exp_f32 v80, v80
    v_exp_f32 v81, v81
    v_exp_f32 v82, v82
    v_exp_f32 v83, v83
    v_smfmac_f32_32x32x32_bf16 v[200:215], v[172:175], v[64:71], v244
    v_exp_f32 v84, v84
    v_exp_f32 v85, v85
    v_exp_f32 v86, v86
    v_exp_f32 v87, v87
    v_mfma_f32_32x32x16_bf16 v[104:119], v[36:39], v[20:23], v[104:119]
    ds_read_b128 v[36:39], v246 offset:21504
    v_exp_f32 v88, v88
    v_exp_f32 v89, v89
    v_exp_f32 v90, v90
    v_exp_f32 v91, v91
    v_mfma_f32_32x32x4_2b_bf16 v[120:151], v[52:53], v[24:25], 0
    v_exp_f32 v92, v92
    v_exp_f32 v93, v93
    v_exp_f32 v94, v94
    v_exp_f32 v95, v95
    v_exp_f32 v96, v96
    v_exp_f32 v97, v97
    v_exp_f32 v98, v98
    v_exp_f32 v99, v99
    v_smfmac_f32_32x32x32_bf16 v[216:231], v[168:171], v[72:79], v244
    v_exp_f32 v100, v100
    v_exp_f32 v101, v101
    v_exp_f32 v102, v102
    v_exp_f32 v103, v103
    s_waitcnt lgkmcnt(3)
    v_smfmac_f32_32x32x32_bf16 v[216:231], v[172:175], v[80:87], v244
    s_mov_b64 exec, s[22:23]
    ds_read_b128 v[168:171], v247 offset:20480
    ds_read_b128 v[172:175], v247 offset:21120
    s_mov_b64 exec, -1
    v_exp_f32 v104, v104
    v_exp_f32 v105, v105
    v_exp_f32 v106, v106
    v_exp_f32 v107, v107
    v_mfma_f32_32x32x16_bf16 v[120:135], v[40:43], v[16:19], v[120:135]
    v_exp_f32 v108, v108
    v_exp_f32 v109, v109
    v_exp_f32 v110, v110
    v_exp_f32 v111, v111
    v_smfmac_f32_32x32x32_bf16 v[200:215], v[176:179], v[88:95], v244
    v_exp_f32 v112, v112
    v_exp_f32 v113, v113
    v_exp_f32 v114, v114
    v_exp_f32 v115, v115
    v_smfmac_f32_32x32x32_bf16 v[200:215], v[180:183], v[96:103], v244
    v_exp_f32 v116, v116
    v_exp_f32 v117, v117
    v_exp_f32 v118, v118
    v_exp_f32 v119, v119
    v_mfma_f32_32x32x16_bf16 v[136:151], v[40:43], v[20:23], v[136:151]
    ds_read_b128 v[40:43], v246 offset:22528
    v_exp_f32 v120, v120
    v_exp_f32 v121, v121
    v_exp_f32 v122, v122
    v_exp_f32 v123, v123
    v_mfma_f32_32x32x4_2b_bf16 v[56:87], v[54:55], v[24:25], 0
    ds_read_b128 v[52:55], v253 offset:25088
    v_exp_f32 v124, v124
    v_exp_f32 v125, v125
    v_exp_f32 v126, v126
    v_exp_f32 v127, v127
    v_exp_f32 v128, v128
    v_exp_f32 v129, v129
    v_exp_f32 v130, v130
    v_exp_f32 v131, v131
    v_smfmac_f32_32x32x32_bf16 v[216:231], v[176:179], v[104:111], v244
    v_exp_f32 v132, v132
    v_exp_f32 v133, v133
    v_exp_f32 v134, v134
    v_exp_f32 v135, v135
    v_smfmac_f32_32x32x32_bf16 v[216:231], v[180:183], v[112:119], v244
    s_mov_b64 exec, s[22:23]
    ds_read_b128 v[176:179], v247 offset:21760
    ds_read_b128 v[180:183], v247 offset:22400
    s_mov_b64 exec, -1
    v_exp_f32 v136, v136
    v_exp_f32 v137, v137
    v_exp_f32 v138, v138
    v_exp_f32 v139, v139
    v_mfma_f32_32x32x16_bf16 v[56:71], v[44:47], v[16:19], v[56:71]
    v_exp_f32 v140, v140
    v_exp_f32 v141, v141
    v_exp_f32 v142, v142
    v_exp_f32 v143, v143
    v_smfmac_f32_32x32x32_bf16 v[200:215], v[184:187], v[120:127], v244
    v_exp_f32 v144, v144
    v_exp_f32 v145, v145
    v_exp_f32 v146, v146
    v_exp_f32 v147, v147
    v_smfmac_f32_32x32x32_bf16 v[200:215], v[188:191], v[128:135], v244
    v_exp_f32 v148, v148
    v_exp_f32 v149, v149
    v_exp_f32 v150, v150
    v_exp_f32 v151, v151
    v_mfma_f32_32x32x16_bf16 v[72:87], v[44:47], v[20:23], v[72:87]
    ds_read_b128 v[44:47], v246 offset:23552
    v_exp_f32 v56, v56
    v_exp_f32 v57, v57
    v_exp_f32 v58, v58
    v_exp_f32 v59, v59
    v_mfma_f32_32x32x4_2b_bf16 v[88:119], v[48:49], v[24:25], 0
    v_exp_f32 v60, v60
    v_exp_f32 v61, v61
    v_exp_f32 v62, v62
    v_exp_f32 v63, v63
    v_exp_f32 v64, v64
    v_exp_f32 v65, v65
    v_exp_f32 v66, v66
    v_exp_f32 v67, v67
    v_smfmac_f32_32x32x32_bf16 v[216:231], v[184:187], v[136:143], v244
    v_exp_f32 v68, v68
    v_exp_f32 v69, v69
    v_exp_f32 v70, v70
    v_exp_f32 v71, v71
    s_waitcnt lgkmcnt(3)
    v_smfmac_f32_32x32x32_bf16 v[216:231], v[188:191], v[144:151], v244
    s_mov_b64 exec, s[22:23]
    ds_read_b128 v[184:187], v247 offset:23040
    ds_read_b128 v[188:191], v247 offset:23680
    s_mov_b64 exec, -1
    v_exp_f32 v72, v72
    v_exp_f32 v73, v73
    v_exp_f32 v74, v74
    v_exp_f32 v75, v75
    v_mfma_f32_32x32x16_bf16 v[88:103], v[32:35], v[16:19], v[88:103]
    v_exp_f32 v76, v76
    v_exp_f32 v77, v77
    v_exp_f32 v78, v78
    v_exp_f32 v79, v79
    v_smfmac_f32_32x32x32_bf16 v[200:215], v[192:195], v[56:63], v244
    v_exp_f32 v80, v80
    v_exp_f32 v81, v81
    v_exp_f32 v82, v82
    v_exp_f32 v83, v83
    v_smfmac_f32_32x32x32_bf16 v[200:215], v[196:199], v[64:71], v244
    v_exp_f32 v84, v84
    v_exp_f32 v85, v85
    v_exp_f32 v86, v86
    v_exp_f32 v87, v87
    v_mfma_f32_32x32x16_bf16 v[104:119], v[32:35], v[20:23], v[104:119]
    ds_read_b128 v[32:35], v246 offset:30720
    v_exp_f32 v88, v88
    v_exp_f32 v89, v89
    v_exp_f32 v90, v90
    v_exp_f32 v91, v91
    v_mfma_f32_32x32x4_2b_bf16 v[120:151], v[50:51], v[24:25], 0
    ds_read_b128 v[48:51], v253 offset:34816
    v_exp_f32 v92, v92
    v_exp_f32 v93, v93
    v_exp_f32 v94, v94
    v_exp_f32 v95, v95
    v_exp_f32 v96, v96
    v_exp_f32 v97, v97
    v_exp_f32 v98, v98
    v_exp_f32 v99, v99
    v_smfmac_f32_32x32x32_bf16 v[216:231], v[192:195], v[72:79], v244
    v_exp_f32 v100, v100
    v_exp_f32 v101, v101
    v_exp_f32 v102, v102
    v_exp_f32 v103, v103
    v_smfmac_f32_32x32x32_bf16 v[216:231], v[196:199], v[80:87], v244
    s_mov_b64 exec, s[22:23]
    ds_read_b128 v[192:195], v247 offset:24320
    ds_read_b128 v[196:199], v247 offset:24960
    s_mov_b64 exec, -1
    v_exp_f32 v104, v104
    v_exp_f32 v105, v105
    v_exp_f32 v106, v106
    v_exp_f32 v107, v107
    v_mfma_f32_32x32x16_bf16 v[120:135], v[36:39], v[16:19], v[120:135]
    v_exp_f32 v108, v108
    v_exp_f32 v109, v109
    v_exp_f32 v110, v110
    v_exp_f32 v111, v111
    v_smfmac_f32_32x32x32_bf16 v[200:215], v[168:171], v[88:95], v244
    v_exp_f32 v112, v112
    v_exp_f32 v113, v113
    v_exp_f32 v114, v114
    v_exp_f32 v115, v115
    v_smfmac_f32_32x32x32_bf16 v[200:215], v[172:175], v[96:103], v244
    v_exp_f32 v116, v116
    v_exp_f32 v117, v117
    v_exp_f32 v118, v118
    v_exp_f32 v119, v119
    v_mfma_f32_32x32x16_bf16 v[136:151], v[36:39], v[20:23], v[136:151]
    ds_read_b128 v[36:39], v246 offset:31744
    v_exp_f32 v120, v120
    v_exp_f32 v121, v121
    v_exp_f32 v122, v122
    v_exp_f32 v123, v123
    v_mfma_f32_32x32x4_2b_bf16 v[56:87], v[52:53], v[24:25], 0
    v_exp_f32 v124, v124
    v_exp_f32 v125, v125
    v_exp_f32 v126, v126
    v_exp_f32 v127, v127
    v_exp_f32 v128, v128
    v_exp_f32 v129, v129
    v_exp_f32 v130, v130
    v_exp_f32 v131, v131
    v_smfmac_f32_32x32x32_bf16 v[216:231], v[168:171], v[104:111], v244
    v_exp_f32 v132, v132
    v_exp_f32 v133, v133
    v_exp_f32 v134, v134
    v_exp_f32 v135, v135
    s_waitcnt lgkmcnt(3)
    v_smfmac_f32_32x32x32_bf16 v[216:231], v[172:175], v[112:119], v244
    s_mov_b64 exec, s[22:23]
    ds_read_b128 v[168:171], v247 offset:30720
    ds_read_b128 v[172:175], v247 offset:31360
    s_mov_b64 exec, -1
    v_exp_f32 v136, v136
    v_exp_f32 v137, v137
    v_exp_f32 v138, v138
    v_exp_f32 v139, v139
    v_mfma_f32_32x32x16_bf16 v[56:71], v[40:43], v[16:19], v[56:71]
    v_exp_f32 v140, v140
    v_exp_f32 v141, v141
    v_exp_f32 v142, v142
    v_exp_f32 v143, v143
    v_smfmac_f32_32x32x32_bf16 v[200:215], v[176:179], v[120:127], v244
    v_exp_f32 v144, v144
    v_exp_f32 v145, v145
    v_exp_f32 v146, v146
    v_exp_f32 v147, v147
    v_smfmac_f32_32x32x32_bf16 v[200:215], v[180:183], v[128:135], v244
    v_exp_f32 v148, v148
    v_exp_f32 v149, v149
    v_exp_f32 v150, v150
    v_exp_f32 v151, v151
    v_mfma_f32_32x32x16_bf16 v[72:87], v[40:43], v[20:23], v[72:87]
    ds_read_b128 v[40:43], v246 offset:32768
    v_exp_f32 v56, v56
    v_exp_f32 v57, v57
    v_exp_f32 v58, v58
    v_exp_f32 v59, v59
    v_mfma_f32_32x32x4_2b_bf16 v[88:119], v[54:55], v[24:25], 0
    ds_read_b128 v[52:55], v253 offset:35328
    v_exp_f32 v60, v60
    v_exp_f32 v61, v61
    v_exp_f32 v62, v62
    v_exp_f32 v63, v63
    v_exp_f32 v64, v64
    v_exp_f32 v65, v65
    v_exp_f32 v66, v66
    v_exp_f32 v67, v67
    v_smfmac_f32_32x32x32_bf16 v[216:231], v[176:179], v[136:143], v244
    v_exp_f32 v68, v68
    v_exp_f32 v69, v69
    v_exp_f32 v70, v70
    v_exp_f32 v71, v71
    v_smfmac_f32_32x32x32_bf16 v[216:231], v[180:183], v[144:151], v244
    s_mov_b64 exec, s[22:23]
    ds_read_b128 v[176:179], v247 offset:32000
    ds_read_b128 v[180:183], v247 offset:32640
    s_mov_b64 exec, -1
    s_setprio 0
    v_exp_f32 v72, v72
    v_exp_f32 v73, v73
    v_exp_f32 v74, v74
    v_exp_f32 v75, v75
    v_mfma_f32_32x32x16_bf16 v[88:103], v[44:47], v[16:19], v[88:103]
    v_exp_f32 v76, v76
    v_exp_f32 v77, v77
    v_exp_f32 v78, v78
    v_exp_f32 v79, v79
    v_smfmac_f32_32x32x32_bf16 v[200:215], v[184:187], v[56:63], v244
    v_exp_f32 v80, v80
    v_exp_f32 v81, v81
    v_exp_f32 v82, v82
    v_exp_f32 v83, v83
    v_smfmac_f32_32x32x32_bf16 v[200:215], v[188:191], v[64:71], v244
    v_exp_f32 v84, v84
    v_exp_f32 v85, v85
    v_exp_f32 v86, v86
    v_exp_f32 v87, v87
    v_mfma_f32_32x32x16_bf16 v[104:119], v[44:47], v[20:23], v[104:119]
    ds_read_b128 v[44:47], v246 offset:33792
    v_exp_f32 v88, v88
    v_exp_f32 v89, v89
    v_exp_f32 v90, v90
    v_exp_f32 v91, v91
    v_mfma_f32_32x32x4_2b_bf16 v[120:151], v[48:49], v[24:25], 0
    v_exp_f32 v92, v92
    v_exp_f32 v93, v93
    v_exp_f32 v94, v94
    v_exp_f32 v95, v95
    v_exp_f32 v96, v96
    v_exp_f32 v97, v97
    v_exp_f32 v98, v98
    v_exp_f32 v99, v99
    v_smfmac_f32_32x32x32_bf16 v[216:231], v[184:187], v[72:79], v244
    v_exp_f32 v100, v100
    v_exp_f32 v101, v101
    v_exp_f32 v102, v102
    v_exp_f32 v103, v103
    s_waitcnt lgkmcnt(3)
    v_smfmac_f32_32x32x32_bf16 v[216:231], v[188:191], v[80:87], v244
    s_mov_b64 exec, s[22:23]
    ds_read_b128 v[184:187], v247 offset:33280
    ds_read_b128 v[188:191], v247 offset:33920
    s_mov_b64 exec, -1
    v_exp_f32 v104, v104
    v_exp_f32 v105, v105
    v_exp_f32 v106, v106
    v_exp_f32 v107, v107
    v_mfma_f32_32x32x16_bf16 v[120:135], v[32:35], v[16:19], v[120:135]
    v_exp_f32 v108, v108
    v_exp_f32 v109, v109
    v_exp_f32 v110, v110
    v_exp_f32 v111, v111
    v_smfmac_f32_32x32x32_bf16 v[200:215], v[192:195], v[88:95], v244
    v_exp_f32 v112, v112
    v_exp_f32 v113, v113
    v_exp_f32 v114, v114
    v_exp_f32 v115, v115
    v_smfmac_f32_32x32x32_bf16 v[200:215], v[196:199], v[96:103], v244
    v_exp_f32 v116, v116
    v_exp_f32 v117, v117
    v_exp_f32 v118, v118
    v_exp_f32 v119, v119
    s_add_u32 s21, s21, 1
    v_add_u32 v246, 30720, v246
    v_add_u32 v247, 30720, v247
    v_add_u32 v253, 30720, v253
    s_cmp_lg_u32 s21, 3
    s_cbranch_scc1 L_p2_loop
    s_lshr_b32 s40, s2, 3
    s_and_b32 s40, s40, 7
    s_mul_i32 s40, s40, 160
    s_mov_b32 s12, s76
    s_mov_b32 s13, s77
    s_mov_b32 s14, 819200
    s_mul_i32 s46, s94, 51200
    s_add_u32 s46, s46, s40
    s_add_u32 s47, s46, 409600
    s_mul_i32 s48, s94, 204800
    s_add_u32 s48, s48, s40
    s_mul_i32 s39, s94, 5120
    s_add_u32 s49, s39, 81920
    s_cmp_lt_u32 s94, 4
    s_cselect_b32 s49, s49, 0x30000
    s_mov_b32 m0, s39
    s_barrier
    v_mfma_f32_32x32x16_bf16 v[136:151], v[32:35], v[20:23], v[136:151]
    ds_read_b128 v[32:35], v246 offset:10240
    s_setprio 1
    v_exp_f32 v120, v120
    v_exp_f32 v121, v121
    v_exp_f32 v122, v122
    v_exp_f32 v123, v123
    v_mfma_f32_32x32x4_2b_bf16 v[56:87], v[50:51], v[24:25], 0
    ds_read_b128 v[48:51], v253 offset:14336
    buffer_load_dwordx4 v232, s[12:15], s46 offen lds
    s_add_u32 m0, s39, 1024
    v_exp_f32 v124, v124
    v_exp_f32 v125, v125
    v_exp_f32 v126, v126
    v_exp_f32 v127, v127
    v_exp_f32 v128, v128
    v_exp_f32 v129, v129
    v_exp_f32 v130, v130
    v_exp_f32 v131, v131
    v_smfmac_f32_32x32x32_bf16 v[216:231], v[192:195], v[104:111], v244
    v_exp_f32 v132, v132
    v_exp_f32 v133, v133
    v_exp_f32 v134, v134
    v_exp_f32 v135, v135
    v_smfmac_f32_32x32x32_bf16 v[216:231], v[196:199], v[112:119], v244
    s_mov_b64 exec, s[22:23]
    ds_read_b128 v[192:195], v247 offset:3840
    ds_read_b128 v[196:199], v247 offset:4480
    s_mov_b64 exec, -1
    v_exp_f32 v136, v136
    v_exp_f32 v137, v137
    v_exp_f32 v138, v138
    v_exp_f32 v139, v139
    v_mfma_f32_32x32x16_bf16 v[56:71], v[36:39], v[16:19], v[56:71]
    v_exp_f32 v140, v140
    v_exp_f32 v141, v141
    v_exp_f32 v142, v142
    v_exp_f32 v143, v143
    v_smfmac_f32_32x32x32_bf16 v[200:215], v[168:171], v[120:127], v244
    v_exp_f32 v144, v144
    v_exp_f32 v145, v145
    v_exp_f32 v146, v146
    v_exp_f32 v147, v147
    v_smfmac_f32_32x32x32_bf16 v[200:215], v[172:175], v[128:135], v244
    v_exp_f32 v148, v148
    v_exp_f32 v149, v149
    v_exp_f32 v150, v150
    v_exp_f32 v151, v151
    v_mfma_f32_32x32x16_bf16 v[72:87], v[36:39], v[20:23], v[72:87]
    ds_read_b128 v[36:39], v246 offset:11264
    v_exp_f32 v56, v56
    v_exp_f32 v57, v57
    v_exp_f32 v58, v58
    v_exp_f32 v59, v59
    v_mfma_f32_32x32x4_2b_bf16 v[88:119], v[52:53], v[24:25], 0
    buffer_load_dwordx4 v233, s[12:15], s46 offen lds
    s_add_u32 m0, s39, 2048
    v_exp_f32 v60, v60
    v_exp_f32 v61, v61
    v_exp_f32 v62, v62
    v_exp_f32 v63, v63
    v_exp_f32 v64, v64
    v_exp_f32 v65, v65
    v_exp_f32 v66, v66
    v_exp_f32 v67, v67
    v_smfmac_f32_32x32x32_bf16 v[216:231], v[168:171], v[136:143], v244
    v_exp_f32 v68, v68
    v_exp_f32 v69, v69
    v_exp_f32 v70, v70
    v_exp_f32 v71, v71
    s_waitcnt lgkmcnt(3)
    v_smfmac_f32_32x32x32_bf16 v[216:231], v[172:175], v[144:151], v244
    s_mov_b64 exec, s[22:23]
    ds_read_b128 v[168:171], v247 offset:10240
    ds_read_b128 v[172:175], v247 offset:10880
    s_mov_b64 exec, -1
    v_exp_f32 v72, v72
    v_exp_f32 v73, v73
    v_exp_f32 v74, v74
    v_exp_f32 v75, v75
    v_mfma_f32_32x32x16_bf16 v[88:103], v[40:43], v[16:19], v[88:103]
    buffer_load_dwordx4 v234, s[12:15], s46 offen lds
    s_add_u32 m0, s39, 3072
    v_exp_f32 v76, v76
    v_exp_f32 v77, v77
    v_exp_f32 v78, v78
    v_exp_f32 v79, v79
    v_smfmac_f32_32x32x32_bf16 v[200:215], v[176:179], v[56:63], v244
    v_exp_f32 v80, v80
    v_exp_f32 v81, v81
    v_exp_f32 v82, v82
    v_exp_f32 v83, v83
    v_smfmac_f32_32x32x32_bf16 v[200:215], v[180:183], v[64:71], v244
    v_exp_f32 v84, v84
    v_exp_f32 v85, v85
    v_exp_f32 v86, v86
    v_exp_f32 v87, v87
    v_mfma_f32_32x32x16_bf16 v[104:119], v[40:43], v[20:23], v[104:119]
    ds_read_b128 v[40:43], v246 offset:12288
    v_exp_f32 v88, v88
    v_exp_f32 v89, v89
    v_exp_f32 v90, v90
    v_exp_f32 v91, v91
    v_mfma_f32_32x32x4_2b_bf16 v[120:151], v[54:55], v[24:25], 0
    ds_read_b128 v[52:55], v253 offset:14848
    v_exp_f32 v92, v92
    v_exp_f32 v93, v93
    v_exp_f32 v94, v94
    v_exp_f32 v95, v95
    v_exp_f32 v96, v96
    v_exp_f32 v97, v97
    v_exp_f32 v98, v98
    v_exp_f32 v99, v99
    v_smfmac_f32_32x32x32_bf16 v[216:231], v[176:179], v[72:79], v244
    v_exp_f32 v100, v100
    v_exp_f32 v101, v101
    v_exp_f32 v102, v102
    v_exp_f32 v103, v103
    v_smfmac_f32_32x32x32_bf16 v[216:231], v[180:183], v[80:87], v244
    s_mov_b64 exec, s[22:23]
    ds_read_b128 v[176:179], v247 offset:11520
    ds_read_b128 v[180:183], v247 offset:12160
    s_mov_b64 exec, -1
    v_exp_f32 v104, v104
    v_exp_f32 v105, v105
    v_exp_f32 v106, v106
    v_exp_f32 v107, v107
    v_mfma_f32_32x32x16_bf16 v[120:135], v[44:47], v[16:19], v[120:135]
    buffer_load_dwordx4 v235, s[12:15], s46 offen lds
    s_add_u32 m0, s39, 4096
    v_exp_f32 v108, v108
    v_exp_f32 v109, v109
    v_exp_f32 v110, v110
    v_exp_f32 v111, v111
    v_smfmac_f32_32x32x32_bf16 v[200:215], v[184:187], v[88:95], v244
    v_exp_f32 v112, v112
    v_exp_f32 v113, v113
    v_exp_f32 v114, v114
    v_exp_f32 v115, v115
    v_smfmac_f32_32x32x32_bf16 v[200:215], v[188:191], v[96:103], v244
    v_exp_f32 v116, v116
    v_exp_f32 v117, v117
    v_exp_f32 v118, v118
    v_exp_f32 v119, v119
    v_mfma_f32_32x32x16_bf16 v[136:151], v[44:47], v[20:23], v[136:151]
    ds_read_b128 v[44:47], v246 offset:13312
    v_exp_f32 v120, v120
    v_exp_f32 v121, v121
    v_exp_f32 v122, v122
    v_exp_f32 v123, v123
    v_mfma_f32_32x32x4_2b_bf16 v[56:87], v[48:49], v[24:25], 0
    buffer_load_dwordx4 v236, s[12:15], s46 offen lds
    s_add_u32 m0, s39, 40960
    v_exp_f32 v124, v124
    v_exp_f32 v125, v125
    v_exp_f32 v126, v126
    v_exp_f32 v127, v127
    v_exp_f32 v128, v128
    v_exp_f32 v129, v129
    v_exp_f32 v130, v130
    v_exp_f32 v131, v131
    v_smfmac_f32_32x32x32_bf16 v[216:231], v[184:187], v[104:111], v244
    v_exp_f32 v132, v132
    v_exp_f32 v133, v133
    v_exp_f32 v134, v134
    v_exp_f32 v135, v135
    s_waitcnt lgkmcnt(3)
    v_smfmac_f32_32x32x32_bf16 v[216:231], v[188:191], v[112:119], v244
    s_mov_b64 exec, s[22:23]
    ds_read_b128 v[184:187], v247 offset:12800
    ds_read_b128 v[188:191], v247 offset:13440
    s_mov_b64 exec, -1
    v_exp_f32 v136, v136
    v_exp_f32 v137, v137
    v_exp_f32 v138, v138
    v_exp_f32 v139, v139
    v_mfma_f32_32x32x16_bf16 v[56:71], v[32:35], v[16:19], v[56:71]
    v_exp_f32 v140, v140
    v_exp_f32 v141, v141
    v_exp_f32 v142, v142
    v_exp_f32 v143, v143
    v_smfmac_f32_32x32x32_bf16 v[200:215], v[192:195], v[120:127], v244
    v_exp_f32 v144, v144
    v_exp_f32 v145, v145
    v_exp_f32 v146, v146
    v_exp_f32 v147, v147
    v_smfmac_f32_32x32x32_bf16 v[200:215], v[196:199], v[128:135], v244
    v_exp_f32 v148, v148
    v_exp_f32 v149, v149
    v_exp_f32 v150, v150
    v_exp_f32 v151, v151
    v_mfma_f32_32x32x16_bf16 v[72:87], v[32:35], v[20:23], v[72:87]
    ds_read_b128 v[32:35], v246 offset:20480
    v_exp_f32 v56, v56
    v_exp_f32 v57, v57
    v_exp_f32 v58, v58
    v_exp_f32 v59, v59
    v_mfma_f32_32x32x4_2b_bf16 v[88:119], v[50:51], v[24:25], 0
    ds_read_b128 v[48:51], v253 offset:24576
    buffer_load_dwordx4 v232, s[12:15], s47 offen lds
    s_add_u32 m0, s39, 41984
    v_exp_f32 v60, v60
    v_exp_f32 v61, v61
    v_exp_f32 v62, v62
    v_exp_f32 v63, v63
    v_exp_f32 v64, v64
    v_exp_f32 v65, v65
    v_exp_f32 v66, v66
    v_exp_f32 v67, v67
    v_smfmac_f32_32x32x32_bf16 v[216:231], v[192:195], v[136:143], v244
    v_exp_f32 v68, v68
    v_exp_f32 v69, v69
    v_exp_f32 v70, v70
    v_exp_f32 v71, v71
    v_smfmac_f32_32x32x32_bf16 v[216:231], v[196:199], v[144:151], v244
    s_mov_b64 exec, s[22:23]
    ds_read_b128 v[192:195], v247 offset:14080
    ds_read_b128 v[196:199], v247 offset:14720
    s_mov_b64 exec, -1
    v_exp_f32 v72, v72
    v_exp_f32 v73, v73
    v_exp_f32 v74, v74
    v_exp_f32 v75, v75
    v_mfma_f32_32x32x16_bf16 v[88:103], v[36:39], v[16:19], v[88:103]
    v_exp_f32 v76, v76
    v_exp_f32 v77, v77
    v_exp_f32 v78, v78
    v_exp_f32 v79, v79
    v_smfmac_f32_32x32x32_bf16 v[200:215], v[168:171], v[56:63], v244
    v_exp_f32 v80, v80
    v_exp_f32 v81, v81
    v_exp_f32 v82, v82
    v_exp_f32 v83, v83
    v_smfmac_f32_32x32x32_bf16 v[200:215], v[172:175], v[64:71], v244
    v_exp_f32 v84, v84
    v_exp_f32 v85, v85
    v_exp_f32 v86, v86
    v_exp_f32 v87, v87
    v_mfma_f32_32x32x16_bf16 v[104:119], v[36:39], v[20:23], v[104:119]
    ds_read_b128 v[36:39], v246 offset:21504
    v_exp_f32 v88, v88
    v_exp_f32 v89, v89
    v_exp_f32 v90, v90
    v_exp_f32 v91, v91
    v_mfma_f32_32x32x4_2b_bf16 v[120:151], v[52:53], v[24:25], 0
    buffer_load_dwordx4 v233, s[12:15], s47 offen lds
    s_add_u32 m0, s39, 43008
    v_exp_f32 v92, v92
    v_exp_f32 v93, v93
    v_exp_f32 v94, v94
    v_exp_f32 v95, v95
    v_exp_f32 v96, v96
    v_exp_f32 v97, v97
    v_exp_f32 v98, v98
    v_exp_f32 v99, v99
    v_smfmac_f32_32x32x32_bf16 v[216:231], v[168:171], v[72:79], v244
    v_exp_f32 v100, v100
    v_exp_f32 v101, v101
    v_exp_f32 v102, v102
    v_exp_f32 v103, v103
    s_waitcnt lgkmcnt(3)
    v_smfmac_f32_32x32x32_bf16 v[216:231], v[172:175], v[80:87], v244
    s_mov_b64 exec, s[22:23]
    ds_read_b128 v[168:171], v247 offset:20480
    ds_read_b128 v[172:175], v247 offset:21120
    s_mov_b64 exec, -1
    v_exp_f32 v104, v104
    v_exp_f32 v105, v105
    v_exp_f32 v106, v106
    v_exp_f32 v107, v107
    v_mfma_f32_32x32x16_bf16 v[120:135], v[40:43], v[16:19], v[120:135]
    buffer_load_dwordx4 v234, s[12:15], s47 offen lds
    s_add_u32 m0, s39, 44032
    v_exp_f32 v108, v108
    v_exp_f32 v109, v109
    v_exp_f32 v110, v110
    v_exp_f32 v111, v111
    v_smfmac_f32_32x32x32_bf16 v[200:215], v[176:179], v[88:95], v244
    v_exp_f32 v112, v112
    v_exp_f32 v113, v113
    v_exp_f32 v114, v114
    v_exp_f32 v115, v115
    v_smfmac_f32_32x32x32_bf16 v[200:215], v[180:183], v[96:103], v244
    v_exp_f32 v116, v116
    v_exp_f32 v117, v117
    v_exp_f32 v118, v118
    v_exp_f32 v119, v119
    v_mfma_f32_32x32x16_bf16 v[136:151], v[40:43], v[20:23], v[136:151]
    ds_read_b128 v[40:43], v246 offset:22528
    v_exp_f32 v120, v120
    v_exp_f32 v121, v121
    v_exp_f32 v122, v122
    v_exp_f32 v123, v123
    v_mfma_f32_32x32x4_2b_bf16 v[56:87], v[54:55], v[24:25], 0
    ds_read_b128 v[52:55], v253 offset:25088
    v_exp_f32 v124, v124
    v_exp_f32 v125, v125
    v_exp_f32 v126, v126
    v_exp_f32 v127, v127
    v_exp_f32 v128, v128
    v_exp_f32 v129, v129
    v_exp_f32 v130, v130
    v_exp_f32 v131, v131
    v_smfmac_f32_32x32x32_bf16 v[216:231], v[176:179], v[104:111], v244
    v_exp_f32 v132, v132
    v_exp_f32 v133, v133
    v_exp_f32 v134, v134
    v_exp_f32 v135, v135
    v_smfmac_f32_32x32x32_bf16 v[216:231], v[180:183], v[112:119], v244
    s_mov_b64 exec, s[22:23]
    ds_read_b128 v[176:179], v247 offset:21760
    ds_read_b128 v[180:183], v247 offset:22400
    s_mov_b64 exec, -1
    v_exp_f32 v136, v136
    v_exp_f32 v137, v137
    v_exp_f32 v138, v138
    v_exp_f32 v139, v139
    v_mfma_f32_32x32x16_bf16 v[56:71], v[44:47], v[16:19], v[56:71]
    buffer_load_dwordx4 v235, s[12:15], s47 offen lds
    s_add_u32 m0, s39, 45056
    v_exp_f32 v140, v140
    v_exp_f32 v141, v141
    v_exp_f32 v142, v142
    v_exp_f32 v143, v143
    v_smfmac_f32_32x32x32_bf16 v[200:215], v[184:187], v[120:127], v244
    v_exp_f32 v144, v144
    v_exp_f32 v145, v145
    v_exp_f32 v146, v146
    v_exp_f32 v147, v147
    v_smfmac_f32_32x32x32_bf16 v[200:215], v[188:191], v[128:135], v244
    v_exp_f32 v148, v148
    v_exp_f32 v149, v149
    v_exp_f32 v150, v150
    v_exp_f32 v151, v151
    v_mfma_f32_32x32x16_bf16 v[72:87], v[44:47], v[20:23], v[72:87]
    ds_read_b128 v[44:47], v246 offset:23552
    v_exp_f32 v56, v56
    v_exp_f32 v57, v57
    v_exp_f32 v58, v58
    v_exp_f32 v59, v59
    v_mfma_f32_32x32x4_2b_bf16 v[88:119], v[48:49], v[24:25], 0
    buffer_load_dwordx4 v236, s[12:15], s47 offen lds
    s_add_u32 m0, s49, 0
    v_exp_f32 v60, v60
    v_exp_f32 v61, v61
    v_exp_f32 v62, v62
    v_exp_f32 v63, v63
    v_exp_f32 v64, v64
    v_exp_f32 v65, v65
    v_exp_f32 v66, v66
    v_exp_f32 v67, v67
    v_smfmac_f32_32x32x32_bf16 v[216:231], v[184:187], v[136:143], v244
    v_exp_f32 v68, v68
    v_exp_f32 v69, v69
    v_exp_f32 v70, v70
    v_exp_f32 v71, v71
    s_waitcnt lgkmcnt(3)
    v_smfmac_f32_32x32x32_bf16 v[216:231], v[188:191], v[144:151], v244
    s_mov_b64 exec, s[22:23]
    ds_read_b128 v[184:187], v247 offset:23040
    ds_read_b128 v[188:191], v247 offset:23680
    s_mov_b64 exec, -1
    v_exp_f32 v72, v72
    v_exp_f32 v73, v73
    v_exp_f32 v74, v74
    v_exp_f32 v75, v75
    v_mfma_f32_32x32x16_bf16 v[88:103], v[32:35], v[16:19], v[88:103]
    v_exp_f32 v76, v76
    v_exp_f32 v77, v77
    v_exp_f32 v78, v78
    v_exp_f32 v79, v79
    v_smfmac_f32_32x32x32_bf16 v[200:215], v[192:195], v[56:63], v244
    v_exp_f32 v80, v80
    v_exp_f32 v81, v81
    v_exp_f32 v82, v82
    v_exp_f32 v83, v83
    v_smfmac_f32_32x32x32_bf16 v[200:215], v[196:199], v[64:71], v244
    v_exp_f32 v84, v84
    v_exp_f32 v85, v85
    v_exp_f32 v86, v86
    v_exp_f32 v87, v87
    v_mfma_f32_32x32x16_bf16 v[104:119], v[32:35], v[20:23], v[104:119]
    ds_read_b128 v[32:35], v246 offset:30720
    v_exp_f32 v88, v88
    v_exp_f32 v89, v89
    v_exp_f32 v90, v90
    v_exp_f32 v91, v91
    v_mfma_f32_32x32x4_2b_bf16 v[120:151], v[50:51], v[24:25], 0
    ds_read_b128 v[48:51], v253 offset:34816
    buffer_load_dwordx4 v237, s[12:15], s48 offen lds
    s_add_u32 m0, s49, 1024
    v_exp_f32 v92, v92
    v_exp_f32 v93, v93
    v_exp_f32 v94, v94
    v_exp_f32 v95, v95
    v_exp_f32 v96, v96
    v_exp_f32 v97, v97
    v_exp_f32 v98, v98
    v_exp_f32 v99, v99
    v_smfmac_f32_32x32x32_bf16 v[216:231], v[192:195], v[72:79], v244
    v_exp_f32 v100, v100
    v_exp_f32 v101, v101
    v_exp_f32 v102, v102
    v_exp_f32 v103, v103
    v_smfmac_f32_32x32x32_bf16 v[216:231], v[196:199], v[80:87], v244
    s_mov_b64 exec, s[22:23]
    ds_read_b128 v[192:195], v247 offset:24320
    ds_read_b128 v[196:199], v247 offset:24960
    s_mov_b64 exec, -1
    v_exp_f32 v104, v104
    v_exp_f32 v105, v105
    v_exp_f32 v106, v106
    v_exp_f32 v107, v107
    v_mfma_f32_32x32x16_bf16 v[120:135], v[36:39], v[16:19], v[120:135]
    v_exp_f32 v108, v108
    v_exp_f32 v109, v109
    v_exp_f32 v110, v110
    v_exp_f32 v111, v111
    v_smfmac_f32_32x32x32_bf16 v[200:215], v[168:171], v[88:95], v244
    v_exp_f32 v112, v112
    v_exp_f32 v113, v113
    v_exp_f32 v114, v114
    v_exp_f32 v115, v115
    v_smfmac_f32_32x32x32_bf16 v[200:215], v[172:175], v[96:103], v244
    v_exp_f32 v116, v116
    v_exp_f32 v117, v117
    v_exp_f32 v118, v118
    v_exp_f32 v119, v119
    v_mfma_f32_32x32x16_bf16 v[136:151], v[36:39], v[20:23], v[136:151]
    ds_read_b128 v[36:39], v246 offset:31744
    v_exp_f32 v120, v120
    v_exp_f32 v121, v121
    v_exp_f32 v122, v122
    v_exp_f32 v123, v123
    v_mfma_f32_32x32x4_2b_bf16 v[56:87], v[52:53], v[24:25], 0
    buffer_load_dwordx4 v238, s[12:15], s48 offen lds
    s_add_u32 m0, s49, 2048
    v_exp_f32 v124, v124
    v_exp_f32 v125, v125
    v_exp_f32 v126, v126
    v_exp_f32 v127, v127
    v_exp_f32 v128, v128
    v_exp_f32 v129, v129
    v_exp_f32 v130, v130
    v_exp_f32 v131, v131
    v_smfmac_f32_32x32x32_bf16 v[216:231], v[168:171], v[104:111], v244
    v_exp_f32 v132, v132
    v_exp_f32 v133, v133
    v_exp_f32 v134, v134
    v_exp_f32 v135, v135
    s_waitcnt lgkmcnt(3)
    v_smfmac_f32_32x32x32_bf16 v[216:231], v[172:175], v[112:119], v244
    s_mov_b64 exec, s[22:23]
    ds_read_b128 v[168:171], v247 offset:30720
    ds_read_b128 v[172:175], v247 offset:31360
    s_mov_b64 exec, -1
    v_exp_f32 v136, v136
    v_exp_f32 v137, v137
    v_exp_f32 v138, v138
    v_exp_f32 v139, v139
    v_mfma_f32_32x32x16_bf16 v[56:71], v[40:43], v[16:19], v[56:71]
    buffer_load_dwordx4 v239, s[12:15], s48 offen lds
    s_add_u32 m0, s49, 3072
    v_exp_f32 v140, v140
    v_exp_f32 v141, v141
    v_exp_f32 v142, v142
    v_exp_f32 v143, v143
    v_smfmac_f32_32x32x32_bf16 v[200:215], v[176:179], v[120:127], v244
    v_exp_f32 v144, v144
    v_exp_f32 v145, v145
    v_exp_f32 v146, v146
    v_exp_f32 v147, v147
    v_smfmac_f32_32x32x32_bf16 v[200:215], v[180:183], v[128:135], v244
    v_exp_f32 v148, v148
    v_exp_f32 v149, v149
    v_exp_f32 v150, v150
    v_exp_f32 v151, v151
    v_mfma_f32_32x32x16_bf16 v[72:87], v[40:43], v[20:23], v[72:87]
    ds_read_b128 v[40:43], v246 offset:32768
    v_exp_f32 v56, v56
    v_exp_f32 v57, v57
    v_exp_f32 v58, v58
    v_exp_f32 v59, v59
    v_mfma_f32_32x32x4_2b_bf16 v[88:119], v[54:55], v[24:25], 0
    ds_read_b128 v[52:55], v253 offset:35328
    v_exp_f32 v60, v60
    v_exp_f32 v61, v61
    v_exp_f32 v62, v62
    v_exp_f32 v63, v63
    v_exp_f32 v64, v64
    v_exp_f32 v65, v65
    v_exp_f32 v66, v66
    v_exp_f32 v67, v67
    v_smfmac_f32_32x32x32_bf16 v[216:231], v[176:179], v[136:143], v244
    v_exp_f32 v68, v68
    v_exp_f32 v69, v69
    v_exp_f32 v70, v70
    v_exp_f32 v71, v71
    v_smfmac_f32_32x32x32_bf16 v[216:231], v[180:183], v[144:151], v244
    s_mov_b64 exec, s[22:23]
    ds_read_b128 v[176:179], v247 offset:32000
    ds_read_b128 v[180:183], v247 offset:32640
    s_mov_b64 exec, -1
    s_setprio 0
    v_exp_f32 v72, v72
    v_exp_f32 v73, v73
    v_exp_f32 v74, v74
    v_exp_f32 v75, v75
    v_mfma_f32_32x32x16_bf16 v[88:103], v[44:47], v[16:19], v[88:103]
    buffer_load_dwordx4 v240, s[12:15], s48 offen lds
    s_add_u32 m0, s49, 4096
    v_exp_f32 v76, v76
    v_exp_f32 v77, v77
    v_exp_f32 v78, v78
    v_exp_f32 v79, v79
    v_smfmac_f32_32x32x32_bf16 v[200:215], v[184:187], v[56:63], v244
    v_exp_f32 v80, v80
    v_exp_f32 v81, v81
    v_exp_f32 v82, v82
    v_exp_f32 v83, v83
    v_smfmac_f32_32x32x32_bf16 v[200:215], v[188:191], v[64:71], v244
    v_exp_f32 v84, v84
    v_exp_f32 v85, v85
    v_exp_f32 v86, v86
    v_exp_f32 v87, v87
    v_mfma_f32_32x32x16_bf16 v[104:119], v[44:47], v[20:23], v[104:119]
    ds_read_b128 v[44:47], v246 offset:33792
    v_exp_f32 v88, v88
    v_exp_f32 v89, v89
    v_exp_f32 v90, v90
    v_exp_f32 v91, v91
    v_mfma_f32_32x32x4_2b_bf16 v[120:151], v[48:49], v[24:25], 0
    buffer_load_dwordx4 v241, s[12:15], s48 offen lds
    s_add_u32 m0, s49, 0
    v_exp_f32 v92, v92
    v_exp_f32 v93, v93
    v_exp_f32 v94, v94
    v_exp_f32 v95, v95
    v_exp_f32 v96, v96
    v_exp_f32 v97, v97
    v_exp_f32 v98, v98
    v_exp_f32 v99, v99
    v_smfmac_f32_32x32x32_bf16 v[216:231], v[184:187], v[72:79], v244
    v_exp_f32 v100, v100
    v_exp_f32 v101, v101
    v_exp_f32 v102, v102
    v_exp_f32 v103, v103
    s_waitcnt lgkmcnt(3)
    v_smfmac_f32_32x32x32_bf16 v[216:231], v[188:191], v[80:87], v244
    s_mov_b64 exec, s[22:23]
    ds_read_b128 v[184:187], v247 offset:33280
    ds_read_b128 v[188:191], v247 offset:33920
    s_mov_b64 exec, -1
    v_exp_f32 v104, v104
    v_exp_f32 v105, v105
    v_exp_f32 v106, v106
    v_exp_f32 v107, v107
    v_mfma_f32_32x32x16_bf16 v[120:135], v[32:35], v[16:19], v[120:135]
    v_exp_f32 v108, v108
    v_exp_f32 v109, v109
    v_exp_f32 v110, v110
    v_exp_f32 v111, v111
    v_smfmac_f32_32x32x32_bf16 v[200:215], v[192:195], v[88:95], v244
    v_exp_f32 v112, v112
    v_exp_f32 v113, v113
    v_exp_f32 v114, v114
    v_exp_f32 v115, v115
    v_smfmac_f32_32x32x32_bf16 v[200:215], v[196:199], v[96:103], v244
    v_exp_f32 v116, v116
    v_exp_f32 v117, v117
    v_exp_f32 v118, v118
    v_exp_f32 v119, v119
    v_mfma_f32_32x32x16_bf16 v[136:151], v[32:35], v[20:23], v[136:151]
    ds_read_b128 v[32:35], v246 offset:40960
    s_setprio 1
    v_exp_f32 v120, v120
    v_exp_f32 v121, v121
    v_exp_f32 v122, v122
    v_exp_f32 v123, v123
    v_mfma_f32_32x32x4_2b_bf16 v[56:87], v[50:51], v[24:25], 0
    ds_read_b128 v[48:51], v253 offset:45056
    v_exp_f32 v124, v124
    v_exp_f32 v125, v125
    v_exp_f32 v126, v126
    v_exp_f32 v127, v127
    v_exp_f32 v128, v128
    v_exp_f32 v129, v129
    v_exp_f32 v130, v130
    v_exp_f32 v131, v131
    v_smfmac_f32_32x32x32_bf16 v[216:231], v[192:195], v[104:111], v244
    v_exp_f32 v132, v132
    v_exp_f32 v133, v133
    v_exp_f32 v134, v134
    v_exp_f32 v135, v135
    v_smfmac_f32_32x32x32_bf16 v[216:231], v[196:199], v[112:119], v244
    s_mov_b64 exec, s[22:23]
    ds_read_b128 v[192:195], v247 offset:34560
    ds_read_b128 v[196:199], v247 offset:35200
    s_mov_b64 exec, -1
    v_exp_f32 v136, v136
    v_exp_f32 v137, v137
    v_exp_f32 v138, v138
    v_exp_f32 v139, v139
    v_mfma_f32_32x32x16_bf16 v[56:71], v[36:39], v[16:19], v[56:71]
    v_exp_f32 v140, v140
    v_exp_f32 v141, v141
    v_exp_f32 v142, v142
    v_exp_f32 v143, v143
    v_smfmac_f32_32x32x32_bf16 v[200:215], v[168:171], v[120:127], v244
    v_exp_f32 v144, v144
    v_exp_f32 v145, v145
    v_exp_f32 v146, v146
    v_exp_f32 v147, v147
    v_smfmac_f32_32x32x32_bf16 v[200:215], v[172:175], v[128:135], v244
    v_exp_f32 v148, v148
    v_exp_f32 v149, v149
    v_exp_f32 v150, v150
    v_exp_f32 v151, v151
    v_mfma_f32_32x32x16_bf16 v[72:87], v[36:39], v[20:23], v[72:87]
    ds_read_b128 v[36:39], v246 offset:41984
    v_exp_f32 v56, v56
    v_exp_f32 v57, v57
    v_exp_f32 v58, v58
    v_exp_f32 v59, v59
    v_mfma_f32_32x32x4_2b_bf16 v[88:119], v[52:53], v[24:25], 0
    v_exp_f32 v60, v60
    v_exp_f32 v61, v61
    v_exp_f32 v62, v62
    v_exp_f32 v63, v63
    v_exp_f32 v64, v64
    v_exp_f32 v65, v65
    v_exp_f32 v66, v66
    v_exp_f32 v67, v67
    v_smfmac_f32_32x32x32_bf16 v[216:231], v[168:171], v[136:143], v244
    v_exp_f32 v68, v68
    v_exp_f32 v69, v69
    v_exp_f32 v70, v70
    v_exp_f32 v71, v71
    s_waitcnt lgkmcnt(3)
    v_smfmac_f32_32x32x32_bf16 v[216:231], v[172:175], v[144:151], v244
    s_mov_b64 exec, s[22:23]
    ds_read_b128 v[168:171], v247 offset:40960
    ds_read_b128 v[172:175], v247 offset:41600
    s_mov_b64 exec, -1
    v_exp_f32 v72, v72
    v_exp_f32 v73, v73
    v_exp_f32 v74, v74
    v_exp_f32 v75, v75
    v_mfma_f32_32x32x16_bf16 v[88:103], v[40:43], v[16:19], v[88:103]
    v_exp_f32 v76, v76
    v_exp_f32 v77, v77
    v_exp_f32 v78, v78
    v_exp_f32 v79, v79
    v_smfmac_f32_32x32x32_bf16 v[200:215], v[176:179], v[56:63], v244
    v_exp_f32 v80, v80
    v_exp_f32 v81, v81
    v_exp_f32 v82, v82
    v_exp_f32 v83, v83
    v_smfmac_f32_32x32x32_bf16 v[200:215], v[180:183], v[64:71], v244
    v_exp_f32 v84, v84
    v_exp_f32 v85, v85
    v_exp_f32 v86, v86
    v_exp_f32 v87, v87
    v_mfma_f32_32x32x16_bf16 v[104:119], v[40:43], v[20:23], v[104:119]
    ds_read_b128 v[40:43], v246 offset:43008
    v_exp_f32 v88, v88
    v_exp_f32 v89, v89
    v_exp_f32 v90, v90
    v_exp_f32 v91, v91
    v_mfma_f32_32x32x4_2b_bf16 v[120:151], v[54:55], v[24:25], 0
    ds_read_b128 v[52:55], v253 offset:45568
    v_exp_f32 v92, v92
    v_exp_f32 v93, v93
    v_exp_f32 v94, v94
    v_exp_f32 v95, v95
    v_exp_f32 v96, v96
    v_exp_f32 v97, v97
    v_exp_f32 v98, v98
    v_exp_f32 v99, v99
    v_smfmac_f32_32x32x32_bf16 v[216:231], v[176:179], v[72:79], v244
    v_exp_f32 v100, v100
    v_exp_f32 v101, v101
    v_exp_f32 v102, v102
    v_exp_f32 v103, v103
    v_smfmac_f32_32x32x32_bf16 v[216:231], v[180:183], v[80:87], v244
    s_mov_b64 exec, s[22:23]
    ds_read_b128 v[176:179], v247 offset:42240
    ds_read_b128 v[180:183], v247 offset:42880
    s_mov_b64 exec, -1
    s_setprio 0
    v_exp_f32 v104, v104
    v_exp_f32 v105, v105
    v_exp_f32 v106, v106
    v_exp_f32 v107, v107
    v_mfma_f32_32x32x16_bf16 v[120:135], v[44:47], v[16:19], v[120:135]
    v_exp_f32 v108, v108
    v_exp_f32 v109, v109
    v_exp_f32 v110, v110
    v_exp_f32 v111, v111
    v_smfmac_f32_32x32x32_bf16 v[200:215], v[184:187], v[88:95], v244
    v_exp_f32 v112, v112
    v_exp_f32 v113, v113
    v_exp_f32 v114, v114
    v_exp_f32 v115, v115
    v_smfmac_f32_32x32x32_bf16 v[200:215], v[188:191], v[96:103], v244
    v_exp_f32 v116, v116
    v_exp_f32 v117, v117
    v_exp_f32 v118, v118
    v_exp_f32 v119, v119
    v_mfma_f32_32x32x16_bf16 v[136:151], v[44:47], v[20:23], v[136:151]
    ds_read_b128 v[44:47], v246 offset:44032
    v_exp_f32 v120, v120
    v_exp_f32 v121, v121
    v_exp_f32 v122, v122
    v_exp_f32 v123, v123
    v_mfma_f32_32x32x4_2b_bf16 v[56:87], v[48:49], v[24:25], 0
    v_exp_f32 v124, v124
    v_exp_f32 v125, v125
    v_exp_f32 v126, v126
    v_exp_f32 v127, v127
    v_exp_f32 v128, v128
    v_exp_f32 v129, v129
    v_exp_f32 v130, v130
    v_exp_f32 v131, v131
    v_smfmac_f32_32x32x32_bf16 v[216:231], v[184:187], v[104:111], v244
    v_exp_f32 v132, v132
    v_exp_f32 v133, v133
    v_exp_f32 v134, v134
    v_exp_f32 v135, v135
    s_waitcnt lgkmcnt(3)
    v_smfmac_f32_32x32x32_bf16 v[216:231], v[188:191], v[112:119], v244
    s_mov_b64 exec, s[22:23]
    ds_read_b128 v[184:187], v247 offset:43520
    ds_read_b128 v[188:191], v247 offset:44160
    s_mov_b64 exec, -1
    v_exp_f32 v136, v136
    v_exp_f32 v137, v137
    v_exp_f32 v138, v138
    v_exp_f32 v139, v139
    v_mfma_f32_32x32x16_bf16 v[56:71], v[32:35], v[16:19], v[56:71]
    v_exp_f32 v140, v140
    v_exp_f32 v141, v141
    v_exp_f32 v142, v142
    v_exp_f32 v143, v143
    v_smfmac_f32_32x32x32_bf16 v[200:215], v[192:195], v[120:127], v244
    v_exp_f32 v144, v144
    v_exp_f32 v145, v145
    v_exp_f32 v146, v146
    v_exp_f32 v147, v147
    v_smfmac_f32_32x32x32_bf16 v[200:215], v[196:199], v[128:135], v244
    v_exp_f32 v148, v148
    v_exp_f32 v149, v149
    v_exp_f32 v150, v150
    v_exp_f32 v151, v151
    v_mfma_f32_32x32x16_bf16 v[72:87], v[32:35], v[20:23], v[72:87]
    s_setprio 1
    v_exp_f32 v56, v56
    v_exp_f32 v57, v57
    v_exp_f32 v58, v58
    v_exp_f32 v59, v59
    v_mfma_f32_32x32x4_2b_bf16 v[88:119], v[50:51], v[24:25], 0
    v_exp_f32 v60, v60
    v_exp_f32 v61, v61
    v_exp_f32 v62, v62
    v_exp_f32 v63, v63
    v_exp_f32 v64, v64
    v_exp_f32 v65, v65
    v_exp_f32 v66, v66
    v_exp_f32 v67, v67
    v_smfmac_f32_32x32x32_bf16 v[216:231], v[192:195], v[136:143], v244
    v_exp_f32 v68, v68
    v_exp_f32 v69, v69
    v_exp_f32 v70, v70
    v_exp_f32 v71, v71
    v_smfmac_f32_32x32x32_bf16 v[216:231], v[196:199], v[144:151], v244
    s_mov_b64 exec, s[22:23]
    ds_read_b128 v[192:195], v247 offset:44800
    ds_read_b128 v[196:199], v247 offset:45440
    s_mov_b64 exec, -1
    v_exp_f32 v72, v72
    v_exp_f32 v73, v73
    v_exp_f32 v74, v74
    v_exp_f32 v75, v75
    v_mfma_f32_32x32x16_bf16 v[88:103], v[36:39], v[16:19], v[88:103]
    v_exp_f32 v76, v76
    v_exp_f32 v77, v77
    v_exp_f32 v78, v78
    v_exp_f32 v79, v79
    v_smfmac_f32_32x32x32_bf16 v[200:215], v[168:171], v[56:63], v244
    v_exp_f32 v80, v80
    v_exp_f32 v81, v81
    v_exp_f32 v82, v82
    v_exp_f32 v83, v83
    v_smfmac_f32_32x32x32_bf16 v[200:215], v[172:175], v[64:71], v244
    v_exp_f32 v84, v84
    v_exp_f32 v85, v85
    v_exp_f32 v86, v86
    v_exp_f32 v87, v87
    v_mfma_f32_32x32x16_bf16 v[104:119], v[36:39], v[20:23], v[104:119]
    v_exp_f32 v88, v88
    v_exp_f32 v89, v89
    v_exp_f32 v90, v90
    v_exp_f32 v91, v91
    v_mfma_f32_32x32x4_2b_bf16 v[120:151], v[52:53], v[24:25], 0
    v_exp_f32 v92, v92
    v_exp_f32 v93, v93
    v_exp_f32 v94, v94
    v_exp_f32 v95, v95
    v_exp_f32 v96, v96
    v_exp_f32 v97, v97
    v_exp_f32 v98, v98
    v_exp_f32 v99, v99
    v_smfmac_f32_32x32x32_bf16 v[216:231], v[168:171], v[72:79], v244
    v_exp_f32 v100, v100
    v_exp_f32 v101, v101
    v_exp_f32 v102, v102
    v_exp_f32 v103, v103
    s_waitcnt lgkmcnt(0)
    v_smfmac_f32_32x32x32_bf16 v[216:231], v[172:175], v[80:87], v244
    v_exp_f32 v104, v104
    v_exp_f32 v105, v105
    v_exp_f32 v106, v106
    v_exp_f32 v107, v107
    v_mfma_f32_32x32x16_bf16 v[120:135], v[40:43], v[16:19], v[120:135]
    v_exp_f32 v108, v108
    v_exp_f32 v109, v109
    v_exp_f32 v110, v110
    v_exp_f32 v111, v111
    v_smfmac_f32_32x32x32_bf16 v[200:215], v[176:179], v[88:95], v244
    v_exp_f32 v112, v112
    v_exp_f32 v113, v113
    v_exp_f32 v114, v114
    v_exp_f32 v115, v115
    v_smfmac_f32_32x32x32_bf16 v[200:215], v[180:183], v[96:103], v244
    v_exp_f32 v116, v116
    v_exp_f32 v117, v117
    v_exp_f32 v118, v118
    v_exp_f32 v119, v119
    v_mfma_f32_32x32x16_bf16 v[136:151], v[40:43], v[20:23], v[136:151]
    v_exp_f32 v120, v120
    v_exp_f32 v121, v121
    v_exp_f32 v122, v122
    v_exp_f32 v123, v123
    v_mfma_f32_32x32x4_2b_bf16 v[56:87], v[54:55], v[24:25], 0
    v_exp_f32 v124, v124
    v_exp_f32 v125, v125
    v_exp_f32 v126, v126
    v_exp_f32 v127, v127
    v_exp_f32 v128, v128
    v_exp_f32 v129, v129
    v_exp_f32 v130, v130
    v_exp_f32 v131, v131
    v_smfmac_f32_32x32x32_bf16 v[216:231], v[176:179], v[104:111], v244
    v_exp_f32 v132, v132
    v_exp_f32 v133, v133
    v_exp_f32 v134, v134
    v_exp_f32 v135, v135
    v_smfmac_f32_32x32x32_bf16 v[216:231], v[180:183], v[112:119], v244
    s_setprio 0
    v_exp_f32 v136, v136
    v_exp_f32 v137, v137
    v_exp_f32 v138, v138
    v_exp_f32 v139, v139
    v_mfma_f32_32x32x16_bf16 v[56:71], v[44:47], v[16:19], v[56:71]
    v_exp_f32 v140, v140
    v_exp_f32 v141, v141
    v_exp_f32 v142, v142
    v_exp_f32 v143, v143
    v_smfmac_f32_32x32x32_bf16 v[200:215], v[184:187], v[120:127], v244
    v_exp_f32 v144, v144
    v_exp_f32 v145, v145
    v_exp_f32 v146, v146
    v_exp_f32 v147, v147
    v_smfmac_f32_32x32x32_bf16 v[200:215], v[188:191], v[128:135], v244
    v_exp_f32 v148, v148
    v_exp_f32 v149, v149
    v_exp_f32 v150, v150
    v_exp_f32 v151, v151
    v_mfma_f32_32x32x16_bf16 v[72:87], v[44:47], v[20:23], v[72:87]
    v_exp_f32 v56, v56
    v_exp_f32 v57, v57
    v_exp_f32 v58, v58
    v_exp_f32 v59, v59
    v_exp_f32 v60, v60
    v_exp_f32 v61, v61
    v_exp_f32 v62, v62
    v_exp_f32 v63, v63
    v_exp_f32 v64, v64
    v_exp_f32 v65, v65
    v_exp_f32 v66, v66
    v_exp_f32 v67, v67
    v_smfmac_f32_32x32x32_bf16 v[216:231], v[184:187], v[136:143], v244
    v_exp_f32 v68, v68
    v_exp_f32 v69, v69
    v_exp_f32 v70, v70
    v_exp_f32 v71, v71
    s_waitcnt lgkmcnt(0)
    v_smfmac_f32_32x32x32_bf16 v[216:231], v[188:191], v[144:151], v244
    v_exp_f32 v72, v72
    v_exp_f32 v73, v73
    v_exp_f32 v74, v74
    v_exp_f32 v75, v75
    v_exp_f32 v76, v76
    v_exp_f32 v77, v77
    v_exp_f32 v78, v78
    v_exp_f32 v79, v79
    v_smfmac_f32_32x32x32_bf16 v[200:215], v[192:195], v[56:63], v244
    v_exp_f32 v80, v80
    v_exp_f32 v81, v81
    v_exp_f32 v82, v82
    v_exp_f32 v83, v83
    v_smfmac_f32_32x32x32_bf16 v[200:215], v[196:199], v[64:71], v244
    v_exp_f32 v84, v84
    v_exp_f32 v85, v85
    v_exp_f32 v86, v86
    v_exp_f32 v87, v87
    s_nop 1
    v_smfmac_f32_32x32x32_bf16 v[216:231], v[192:195], v[72:79], v244
    v_smfmac_f32_32x32x32_bf16 v[216:231], v[196:199], v[80:87], v244
    s_setprio 0
    s_lshl_b32 s35, s30, 4
    s_lshl_b32 s36, s94, 1
    s_add_u32 s35, s35, s36
    s_mul_i32 s35, s35, 40960
    s_lshr_b32 s36, s29, 1
    s_lshl_b32 s36, s36, 9
    s_and_b32 s37, s29, 1
    s_lshl_b32 s37, s37, 3
    s_add_u32 s36, s36, s37
    s_add_u32 s36, s36, 32768
    s_add_u32 s33, s35, s36
    v_lshrrev_b32 v12, 5, v1
    v_mul_u32_u24 v12, 40960, v12
    v_add_u32 v12, v12, v248
    s_lshl_b32 s36, s29, 10
    s_add_u32 s35, s35, s36
    s_mov_b32 s36, 0x37800000
    s_mov_b32 s37, 0x5d800000
    s_mov_b32 s38, 0x7f800000
    s_mov_b64 s[46:47], -1
    v_cmp_le_f32 vcc, s36, v210
    s_and_b64 s[46:47], s[46:47], vcc
    v_cmp_ge_f32 vcc, s37, v210
    s_and_b64 s[46:47], s[46:47], vcc
    v_add_f32_e64 v10, abs(v200), abs(v201)
    v_add_f32_e64 v10, v10, abs(v202)
    v_add_f32_e64 v10, v10, abs(v203)
    v_add_f32_e64 v10, v10, abs(v204)
    v_add_f32_e64 v10, v10, abs(v205)
    v_add_f32_e64 v10, v10, abs(v206)
    v_add_f32_e64 v10, v10, abs(v207)
    v_add_f32_e64 v10, v10, abs(v208)
    v_add_f32_e64 v10, v10, abs(v209)
    v_cmp_gt_f32 vcc, s38, v10
    s_and_b64 s[46:47], s[46:47], vcc
    v_cmp_le_f32 vcc, s36, v226
    s_and_b64 s[46:47], s[46:47], vcc
    v_cmp_ge_f32 vcc, s37, v226
    s_and_b64 s[46:47], s[46:47], vcc
    v_add_f32_e64 v10, abs(v216), abs(v217)
    v_add_f32_e64 v10, v10, abs(v218)
    v_add_f32_e64 v10, v10, abs(v219)
    v_add_f32_e64 v10, v10, abs(v220)
    v_add_f32_e64 v10, v10, abs(v221)
    v_add_f32_e64 v10, v10, abs(v222)
    v_add_f32_e64 v10, v10, abs(v223)
    v_add_f32_e64 v10, v10, abs(v224)
    v_add_f32_e64 v10, v10, abs(v225)
    v_cmp_gt_f32 vcc, s38, v10
    s_and_b64 s[46:47], s[46:47], vcc
    s_cmp_eq_u64 s[46:47], -1
    s_cbranch_scc0 L_p2_slow
L_p2_fin:
    v_rcp_f32 v10, v210
    s_nop 0
    v_mul_f32 v200, v200, v10
    v_mul_f32 v201, v201, v10
    v_mul_f32 v202, v202, v10
    v_mul_f32 v203, v203, v10
    v_mul_f32 v204, v204, v10
    v_mul_f32 v205, v205, v10
    v_mul_f32 v206, v206, v10
    v_mul_f32 v207, v207, v10
    v_mul_f32 v208, v208, v10
    v_mul_f32 v209, v209, v10
    v_cvt_pk_bf16_f32 v200, v200, v201
    v_cvt_pk_bf16_f32 v201, v202, v203
    v_cvt_pk_bf16_f32 v202, v204, v205
    v_cvt_pk_bf16_f32 v203, v206, v207
    v_cvt_pk_bf16_f32 v14, v208, v209
    buffer_store_dwordx4 v[200:203], v242, s[16:19], s35 offen sc1
    v_rcp_f32 v10, v226
    s_nop 0
    v_mul_f32 v216, v216, v10
    v_mul_f32 v217, v217, v10
    v_mul_f32 v218, v218, v10
    v_mul_f32 v219, v219, v10
    v_mul_f32 v220, v220, v10
    v_mul_f32 v221, v221, v10
    v_mul_f32 v222, v222, v10
    v_mul_f32 v223, v223, v10
    v_mul_f32 v224, v224, v10
    v_mul_f32 v225, v225, v10
    v_cvt_pk_bf16_f32 v216, v216, v217
    v_cvt_pk_bf16_f32 v217, v218, v219
    v_cvt_pk_bf16_f32 v218, v220, v221
    v_cvt_pk_bf16_f32 v219, v222, v223
    v_cvt_pk_bf16_f32 v15, v224, v225
    s_add_u32 s36, s35, 40960
    s_mov_b32 s63, 0
    buffer_store_dwordx4 v[216:219], v242, s[16:19], s36 offen sc1
    v_permlane32_swap_b32 v14, v15
    buffer_store_dwordx2 v[14:15], v12, s[16:19], s33 offen sc1
    s_lshl_b32 s40, s28, 2
    s_add_u32 s40, s40, s30
    s_lshl_b32 s40, s40, 8
    s_lshl_b32 s41, s29, 3
    s_add_u32 s40, s40, s41
    s_add_u32 s40, s40, 22614016
    s_and_b32 s41, s2, 7
    s_lshl_b32 s41, s41, 8
    s_add_u32 s41, s41, 22614016
    v_and_b32 v22, 31, v1
    v_lshl_add_u32 v22, v22, 3, s41
    s_cmp_lg_u32 s94, 7
    s_cbranch_scc1 L_p2_nq
L_p2_nq:
    s_waitcnt vmcnt(0)
    s_barrier
    s_cmp_lg_u32 s94, 0
    s_cbranch_scc1 L_p3_go
    v_mov_b32 v8, s40
    v_mov_b32 v10, s90
    v_mov_b32 v11, s91
    s_mov_b64 exec, 1
    s_cmp_lg_u32 s63, 0
    s_cbranch_scc1 L_sig_2
    global_store_dwordx2 v8, v[10:11], s[88:89] sc1
    s_branch L_sigd_2
L_sig_2:
    global_store_dwordx2 v8, v[10:11], s[88:89]
L_sigd_2:
    s_mov_b64 exec, -1
L_p3_go:
    s_and_b32 s34, s2, 7
    s_lshr_b32 s33, s2, 3
    s_lshr_b32 s28, s34, 2
    s_and_b32 s34, s34, 3
    s_and_b32 s30, s33, 7
    s_lshr_b32 s35, s33, 3
    s_lshl_b32 s29, s34, 2
    s_add_u32 s29, s29, s35
    s_lshr_b32 s20, s94, 1
    s_and_b32 s21, s94, 1
    s_lshl_b32 s25, s29, 2
    s_add_u32 s25, s25, s20
    s_mul_i32 s25, s25, 40960
    s_lshl_b32 s35, s21, 8
    s_add_u32 s25, s25, s35
    s_mul_i32 s26, s30, 160
    s_mov_b32 s10, 2621440
    s_mov_b32 s11, 0x20000
    s_mul_i32 s35, s28, 2621440
    s_add_u32 s35, s35, 15728640
    s_add_u32 s8, s88, s35
    s_addc_u32 s9, s89, 0
    s_cmp_ge_u32 s30, 5
    s_cselect_b32 s35, 5, 0
    s_sub_u32 s42, s30, s35
    s_mov_b32 s42, 0
    v_lshrrev_b32 v8, 4, v1
    v_lshrrev_b32 v10, 1, v8
    v_lshlrev_b32 v10, 4, v10
    v_and_b32 v11, 1, v8
    v_lshl_add_u32 v10, v11, 2, v10
    v_bfe_u32 v11, v1, 2, 2
    v_add_u32 v10, v10, v11
    v_mul_u32_u24 v10, 160, v10
    v_and_b32 v11, 3, v1
    v_lshl_add_u32 v3, v11, 3, v10
    s_lshl_b32 s44, s42, 13
    s_add_u32 s44, s44, s25
    s_add_u32 s64, s44, 4096
    s_mul_i32 s35, s42, 20480
    v_add_u32 v16, s35, v3
    s_add_u32 s42, s42, 1
    s_cmp_eq_u32 s42, 5
    s_cselect_b32 s42, 0, s42
    s_lshl_b32 s45, s42, 13
    s_add_u32 s45, s45, s25
    s_add_u32 s65, s45, 4096
    s_mul_i32 s35, s42, 20480
    v_add_u32 v17, s35, v3
    s_add_u32 s42, s42, 1
    s_cmp_eq_u32 s42, 5
    s_cselect_b32 s42, 0, s42
    s_lshl_b32 s46, s42, 13
    s_add_u32 s46, s46, s25
    s_add_u32 s66, s46, 4096
    s_mul_i32 s35, s42, 20480
    v_add_u32 v18, s35, v3
    s_add_u32 s42, s42, 1
    s_cmp_eq_u32 s42, 5
    s_cselect_b32 s42, 0, s42
    s_lshl_b32 s47, s42, 13
    s_add_u32 s47, s47, s25
    s_add_u32 s67, s47, 4096
    s_mul_i32 s35, s42, 20480
    v_add_u32 v19, s35, v3
    s_add_u32 s42, s42, 1
    s_cmp_eq_u32 s42, 5
    s_cselect_b32 s42, 0, s42
    s_lshl_b32 s48, s42, 13
    s_add_u32 s48, s48, s25
    s_add_u32 s68, s48, 4096
    s_mul_i32 s35, s42, 20480
    v_add_u32 v20, s35, v3
    s_add_u32 s42, s42, 1
    s_cmp_eq_u32 s42, 5
    s_cselect_b32 s42, 0, s42
    v_and_b32 v9, 15, v1
    v_lshlrev_b32 v2, 9, v8
    v_lshl_add_u32 v2, v9, 4, v2
    v_and_b32 v10, 3, v1
    v_bfe_u32 v11, v1, 2, 1
    v_lshl_or_b32 v10, v11, 4, v10
    v_bfe_u32 v11, v1, 3, 1
    v_lshl_or_b32 v10, v11, 2, v10
    v_mul_u32_u24 v10, 2560, v10
    v_lshl_add_u32 v5, v8, 3, v10
    v_and_b32 v11, 1, v8
    v_lshl_add_u32 v10, v11, 5, v10
    v_lshrrev_b32 v11, 1, v8
    v_lshl_add_u32 v4, v11, 4, v10
    s_mov_b32 s18, 5242880
    s_mov_b32 s19, 0x20000
    s_lshl_b32 s40, s29, 7
    s_lshl_b32 s41, s20, 5
    s_add_u32 s40, s40, s41
    s_lshl_b32 s41, s21, 3
    s_add_u32 s40, s40, s41
    s_mul_i32 s40, s40, 2560
    s_mul_i32 s41, s28, 1280
    s_add_u32 s40, s40, s41
    s_add_u32 s40, s40, s26
    s_mov_b32 s16, s78
    s_mov_b32 s17, s79
    ds_read_b64_tr_b16 v[168:169], v16 offset:0
    ds_read_b64_tr_b16 v[170:171], v16 offset:1280
    ds_read_b64_tr_b16 v[172:173], v16 offset:32
    ds_read_b64_tr_b16 v[174:175], v16 offset:1312
    ds_read_b64_tr_b16 v[176:177], v16 offset:64
    ds_read_b64_tr_b16 v[178:179], v16 offset:1344
    ds_read_b64_tr_b16 v[180:181], v16 offset:96
    ds_read_b64_tr_b16 v[182:183], v16 offset:1376
    ds_read_b64_tr_b16 v[184:185], v16 offset:128
    ds_read_b64_tr_b16 v[186:187], v16 offset:1408
    s_waitcnt lgkmcnt(4)
    ds_read_b64_tr_b16 v[188:189], v16 offset:5120
    ds_read_b64_tr_b16 v[190:191], v16 offset:6400
    ds_read_b64_tr_b16 v[192:193], v16 offset:5152
    ds_read_b64_tr_b16 v[194:195], v16 offset:6432
    ds_read_b64_tr_b16 v[196:197], v16 offset:5184
    ds_read_b64_tr_b16 v[198:199], v16 offset:6464
    ds_read_b64_tr_b16 v[200:201], v16 offset:5216
    ds_read_b64_tr_b16 v[202:203], v16 offset:6496
    ds_read_b64_tr_b16 v[204:205], v16 offset:5248
    ds_read_b64_tr_b16 v[206:207], v16 offset:6528
    s_waitcnt lgkmcnt(4)
    ds_read_b64_tr_b16 v[208:209], v16 offset:10240
    ds_read_b64_tr_b16 v[210:211], v16 offset:11520
    ds_read_b64_tr_b16 v[212:213], v16 offset:10272
    ds_read_b64_tr_b16 v[214:215], v16 offset:11552
    ds_read_b64_tr_b16 v[216:217], v16 offset:10304
    ds_read_b64_tr_b16 v[218:219], v16 offset:11584
    ds_read_b64_tr_b16 v[220:221], v16 offset:10336
    ds_read_b64_tr_b16 v[222:223], v16 offset:11616
    ds_read_b64_tr_b16 v[224:225], v16 offset:10368
    ds_read_b64_tr_b16 v[226:227], v16 offset:11648
    s_waitcnt lgkmcnt(4)
    ds_read_b64_tr_b16 v[228:229], v16 offset:15360
    ds_read_b64_tr_b16 v[230:231], v16 offset:16640
    ds_read_b64_tr_b16 v[232:233], v16 offset:15392
    ds_read_b64_tr_b16 v[234:235], v16 offset:16672
    ds_read_b64_tr_b16 v[236:237], v16 offset:15424
    ds_read_b64_tr_b16 v[238:239], v16 offset:16704
    ds_read_b64_tr_b16 v[240:241], v16 offset:15456
    ds_read_b64_tr_b16 v[242:243], v16 offset:16736
    ds_read_b64_tr_b16 v[244:245], v16 offset:15488
    ds_read_b64_tr_b16 v[246:247], v16 offset:16768
    s_waitcnt lgkmcnt(4)
    ds_read_b64_tr_b16 v[28:29], v17 offset:0
    ds_read_b64_tr_b16 v[30:31], v17 offset:1280
    ds_read_b64_tr_b16 v[32:33], v17 offset:32
    ds_read_b64_tr_b16 v[34:35], v17 offset:1312
    ds_read_b64_tr_b16 v[36:37], v17 offset:64
    ds_read_b64_tr_b16 v[38:39], v17 offset:1344
    ds_read_b64_tr_b16 v[40:41], v17 offset:96
    ds_read_b64_tr_b16 v[42:43], v17 offset:1376
    ds_read_b64_tr_b16 v[44:45], v17 offset:128
    ds_read_b64_tr_b16 v[46:47], v17 offset:1408
    s_cmp_lg_u32 s94, 7
    s_cbranch_scc1 L_p3_np
    s_mov_b32 s95, 1048576
L_poll_2:
    global_load_dwordx2 v[24:25], v22, s[88:89] sc1
    s_waitcnt vmcnt(0)
L_pollc_2:
    v_cmp_eq_u64 vcc, s[90:91], v[24:25]
    s_sub_u32 s95, s95, 1
    s_cmp_eq_u64 vcc, -1
    s_cbranch_scc1 L_polled_2
    s_sleep 1
    s_cmp_lg_u32 s95, 0
    s_cbranch_scc1 L_poll_2
L_polled_2:
L_p3_np:
    s_barrier
    buffer_load_dwordx4 v[88:91], v2, s[8:11], s44 offen offset:0 sc1
    buffer_load_dwordx4 v[92:95], v2, s[8:11], s44 offen offset:2048 sc1
    buffer_load_dwordx4 v[96:99], v2, s[8:11], s64 offen offset:0 sc1
    buffer_load_dwordx4 v[100:103], v2, s[8:11], s64 offen offset:2048 sc1
    s_barrier
    buffer_load_dwordx4 v[104:107], v2, s[8:11], s45 offen offset:0 sc1
    buffer_load_dwordx4 v[108:111], v2, s[8:11], s45 offen offset:2048 sc1
    buffer_load_dwordx4 v[112:115], v2, s[8:11], s65 offen offset:0 sc1
    buffer_load_dwordx4 v[116:119], v2, s[8:11], s65 offen offset:2048 sc1
    s_waitcnt vmcnt(7)
    s_waitcnt lgkmcnt(0)
    v_mfma_f32_16x16x32_bf16 v[68:71], v[168:171], v[88:91], 0
    v_mfma_f32_16x16x32_bf16 v[72:75], v[172:175], v[88:91], 0
    v_mfma_f32_16x16x32_bf16 v[76:79], v[176:179], v[88:91], 0
    v_mfma_f32_16x16x32_bf16 v[80:83], v[180:183], v[88:91], 0
    v_mfma_f32_16x16x32_bf16 v[84:87], v[184:187], v[88:91], 0
    s_waitcnt vmcnt(6)
    v_mfma_f32_16x16x32_bf16 v[68:71], v[188:191], v[92:95], v[68:71]
    v_mfma_f32_16x16x32_bf16 v[72:75], v[192:195], v[92:95], v[72:75]
    v_mfma_f32_16x16x32_bf16 v[76:79], v[196:199], v[92:95], v[76:79]
    v_mfma_f32_16x16x32_bf16 v[80:83], v[200:203], v[92:95], v[80:83]
    v_mfma_f32_16x16x32_bf16 v[84:87], v[204:207], v[92:95], v[84:87]
    s_waitcnt vmcnt(5)
    v_mfma_f32_16x16x32_bf16 v[68:71], v[208:211], v[96:99], v[68:71]
    v_mfma_f32_16x16x32_bf16 v[72:75], v[212:215], v[96:99], v[72:75]
    v_mfma_f32_16x16x32_bf16 v[76:79], v[216:219], v[96:99], v[76:79]
    v_mfma_f32_16x16x32_bf16 v[80:83], v[220:223], v[96:99], v[80:83]
    v_mfma_f32_16x16x32_bf16 v[84:87], v[224:227], v[96:99], v[84:87]
    s_waitcnt vmcnt(4)
    v_mfma_f32_16x16x32_bf16 v[68:71], v[228:231], v[100:103], v[68:71]
    v_mfma_f32_16x16x32_bf16 v[72:75], v[232:235], v[100:103], v[72:75]
    v_mfma_f32_16x16x32_bf16 v[76:79], v[236:239], v[100:103], v[76:79]
    v_mfma_f32_16x16x32_bf16 v[80:83], v[240:243], v[100:103], v[80:83]
    v_mfma_f32_16x16x32_bf16 v[84:87], v[244:247], v[100:103], v[84:87]
    s_barrier
    buffer_load_dwordx4 v[120:123], v2, s[8:11], s46 offen offset:0 sc1
    buffer_load_dwordx4 v[124:127], v2, s[8:11], s46 offen offset:2048 sc1
    buffer_load_dwordx4 v[128:131], v2, s[8:11], s66 offen offset:0 sc1
    buffer_load_dwordx4 v[132:135], v2, s[8:11], s66 offen offset:2048 sc1
    s_waitcnt vmcnt(7)
    v_mfma_f32_16x16x32_bf16 v[68:71], v[28:31], v[104:107], v[68:71]
    ds_read_b64_tr_b16 v[48:49], v17 offset:5120
    ds_read_b64_tr_b16 v[50:51], v17 offset:6400
    v_mfma_f32_16x16x32_bf16 v[72:75], v[32:35], v[104:107], v[72:75]
    ds_read_b64_tr_b16 v[52:53], v17 offset:5152
    ds_read_b64_tr_b16 v[54:55], v17 offset:6432
    v_mfma_f32_16x16x32_bf16 v[76:79], v[36:39], v[104:107], v[76:79]
    ds_read_b64_tr_b16 v[56:57], v17 offset:5184
    ds_read_b64_tr_b16 v[58:59], v17 offset:6464
    v_mfma_f32_16x16x32_bf16 v[80:83], v[40:43], v[104:107], v[80:83]
    ds_read_b64_tr_b16 v[60:61], v17 offset:5216
    ds_read_b64_tr_b16 v[62:63], v17 offset:6496
    v_mfma_f32_16x16x32_bf16 v[84:87], v[44:47], v[104:107], v[84:87]
    ds_read_b64_tr_b16 v[64:65], v17 offset:5248
    ds_read_b64_tr_b16 v[66:67], v17 offset:6528
    s_waitcnt vmcnt(6)
    s_waitcnt lgkmcnt(4)
    v_mfma_f32_16x16x32_bf16 v[68:71], v[48:51], v[108:111], v[68:71]
    ds_read_b64_tr_b16 v[28:29], v17 offset:10240
    ds_read_b64_tr_b16 v[30:31], v17 offset:11520
    v_mfma_f32_16x16x32_bf16 v[72:75], v[52:55], v[108:111], v[72:75]
    ds_read_b64_tr_b16 v[32:33], v17 offset:10272
    ds_read_b64_tr_b16 v[34:35], v17 offset:11552
    v_mfma_f32_16x16x32_bf16 v[76:79], v[56:59], v[108:111], v[76:79]
    ds_read_b64_tr_b16 v[36:37], v17 offset:10304
    ds_read_b64_tr_b16 v[38:39], v17 offset:11584
    s_waitcnt lgkmcnt(6)
    v_mfma_f32_16x16x32_bf16 v[80:83], v[60:63], v[108:111], v[80:83]
    ds_read_b64_tr_b16 v[40:41], v17 offset:10336
    ds_read_b64_tr_b16 v[42:43], v17 offset:11616
    v_mfma_f32_16x16x32_bf16 v[84:87], v[64:67], v[108:111], v[84:87]
    ds_read_b64_tr_b16 v[44:45], v17 offset:10368
    ds_read_b64_tr_b16 v[46:47], v17 offset:11648
    s_waitcnt vmcnt(5)
    s_waitcnt lgkmcnt(4)
    v_mfma_f32_16x16x32_bf16 v[68:71], v[28:31], v[112:115], v[68:71]
    ds_read_b64_tr_b16 v[48:49], v17 offset:15360
    ds_read_b64_tr_b16 v[50:51], v17 offset:16640
    v_mfma_f32_16x16x32_bf16 v[72:75], v[32:35], v[112:115], v[72:75]
    ds_read_b64_tr_b16 v[52:53], v17 offset:15392
    ds_read_b64_tr_b16 v[54:55], v17 offset:16672
    v_mfma_f32_16x16x32_bf16 v[76:79], v[36:39], v[112:115], v[76:79]
    ds_read_b64_tr_b16 v[56:57], v17 offset:15424
    ds_read_b64_tr_b16 v[58:59], v17 offset:16704
    s_waitcnt lgkmcnt(6)
    v_mfma_f32_16x16x32_bf16 v[80:83], v[40:43], v[112:115], v[80:83]
    ds_read_b64_tr_b16 v[60:61], v17 offset:15456
    ds_read_b64_tr_b16 v[62:63], v17 offset:16736
    v_mfma_f32_16x16x32_bf16 v[84:87], v[44:47], v[112:115], v[84:87]
    ds_read_b64_tr_b16 v[64:65], v17 offset:15488
    ds_read_b64_tr_b16 v[66:67], v17 offset:16768
    s_waitcnt vmcnt(4)
    s_waitcnt lgkmcnt(4)
    v_mfma_f32_16x16x32_bf16 v[68:71], v[48:51], v[116:119], v[68:71]
    ds_read_b64_tr_b16 v[28:29], v18 offset:0
    ds_read_b64_tr_b16 v[30:31], v18 offset:1280
    v_mfma_f32_16x16x32_bf16 v[72:75], v[52:55], v[116:119], v[72:75]
    ds_read_b64_tr_b16 v[32:33], v18 offset:32
    ds_read_b64_tr_b16 v[34:35], v18 offset:1312
    v_mfma_f32_16x16x32_bf16 v[76:79], v[56:59], v[116:119], v[76:79]
    ds_read_b64_tr_b16 v[36:37], v18 offset:64
    ds_read_b64_tr_b16 v[38:39], v18 offset:1344
    s_waitcnt lgkmcnt(6)
    v_mfma_f32_16x16x32_bf16 v[80:83], v[60:63], v[116:119], v[80:83]
    ds_read_b64_tr_b16 v[40:41], v18 offset:96
    ds_read_b64_tr_b16 v[42:43], v18 offset:1376
    v_mfma_f32_16x16x32_bf16 v[84:87], v[64:67], v[116:119], v[84:87]
    ds_read_b64_tr_b16 v[44:45], v18 offset:128
    ds_read_b64_tr_b16 v[46:47], v18 offset:1408
    s_barrier
    buffer_load_dwordx4 v[136:139], v2, s[8:11], s47 offen offset:0 sc1
    buffer_load_dwordx4 v[140:143], v2, s[8:11], s47 offen offset:2048 sc1
    buffer_load_dwordx4 v[144:147], v2, s[8:11], s67 offen offset:0 sc1
    buffer_load_dwordx4 v[148:151], v2, s[8:11], s67 offen offset:2048 sc1
    s_waitcnt vmcnt(7)
    s_waitcnt lgkmcnt(4)
    v_mfma_f32_16x16x32_bf16 v[68:71], v[28:31], v[120:123], v[68:71]
    ds_read_b64_tr_b16 v[48:49], v18 offset:5120
    ds_read_b64_tr_b16 v[50:51], v18 offset:6400
    v_mfma_f32_16x16x32_bf16 v[72:75], v[32:35], v[120:123], v[72:75]
    ds_read_b64_tr_b16 v[52:53], v18 offset:5152
    ds_read_b64_tr_b16 v[54:55], v18 offset:6432
    v_mfma_f32_16x16x32_bf16 v[76:79], v[36:39], v[120:123], v[76:79]
    ds_read_b64_tr_b16 v[56:57], v18 offset:5184
    ds_read_b64_tr_b16 v[58:59], v18 offset:6464
    s_waitcnt lgkmcnt(6)
    v_mfma_f32_16x16x32_bf16 v[80:83], v[40:43], v[120:123], v[80:83]
    ds_read_b64_tr_b16 v[60:61], v18 offset:5216
    ds_read_b64_tr_b16 v[62:63], v18 offset:6496
    v_mfma_f32_16x16x32_bf16 v[84:87], v[44:47], v[120:123], v[84:87]
    ds_read_b64_tr_b16 v[64:65], v18 offset:5248
    ds_read_b64_tr_b16 v[66:67], v18 offset:6528
    s_waitcnt vmcnt(6)
    s_waitcnt lgkmcnt(4)
    v_mfma_f32_16x16x32_bf16 v[68:71], v[48:51], v[124:127], v[68:71]
    ds_read_b64_tr_b16 v[28:29], v18 offset:10240
    ds_read_b64_tr_b16 v[30:31], v18 offset:11520
    v_mfma_f32_16x16x32_bf16 v[72:75], v[52:55], v[124:127], v[72:75]
    ds_read_b64_tr_b16 v[32:33], v18 offset:10272
    ds_read_b64_tr_b16 v[34:35], v18 offset:11552
    v_mfma_f32_16x16x32_bf16 v[76:79], v[56:59], v[124:127], v[76:79]
    ds_read_b64_tr_b16 v[36:37], v18 offset:10304
    ds_read_b64_tr_b16 v[38:39], v18 offset:11584
    s_waitcnt lgkmcnt(6)
    v_mfma_f32_16x16x32_bf16 v[80:83], v[60:63], v[124:127], v[80:83]
    ds_read_b64_tr_b16 v[40:41], v18 offset:10336
    ds_read_b64_tr_b16 v[42:43], v18 offset:11616
    v_mfma_f32_16x16x32_bf16 v[84:87], v[64:67], v[124:127], v[84:87]
    ds_read_b64_tr_b16 v[44:45], v18 offset:10368
    ds_read_b64_tr_b16 v[46:47], v18 offset:11648
    s_waitcnt vmcnt(5)
    s_waitcnt lgkmcnt(4)
    v_mfma_f32_16x16x32_bf16 v[68:71], v[28:31], v[128:131], v[68:71]
    ds_read_b64_tr_b16 v[48:49], v18 offset:15360
    ds_read_b64_tr_b16 v[50:51], v18 offset:16640
    v_mfma_f32_16x16x32_bf16 v[72:75], v[32:35], v[128:131], v[72:75]
    ds_read_b64_tr_b16 v[52:53], v18 offset:15392
    ds_read_b64_tr_b16 v[54:55], v18 offset:16672
    v_mfma_f32_16x16x32_bf16 v[76:79], v[36:39], v[128:131], v[76:79]
    ds_read_b64_tr_b16 v[56:57], v18 offset:15424
    ds_read_b64_tr_b16 v[58:59], v18 offset:16704
    s_waitcnt lgkmcnt(6)
    v_mfma_f32_16x16x32_bf16 v[80:83], v[40:43], v[128:131], v[80:83]
    ds_read_b64_tr_b16 v[60:61], v18 offset:15456
    ds_read_b64_tr_b16 v[62:63], v18 offset:16736
    v_mfma_f32_16x16x32_bf16 v[84:87], v[44:47], v[128:131], v[84:87]
    ds_read_b64_tr_b16 v[64:65], v18 offset:15488
    ds_read_b64_tr_b16 v[66:67], v18 offset:16768
    s_waitcnt vmcnt(4)
    s_waitcnt lgkmcnt(4)
    v_mfma_f32_16x16x32_bf16 v[68:71], v[48:51], v[132:135], v[68:71]
    ds_read_b64_tr_b16 v[28:29], v19 offset:0
    ds_read_b64_tr_b16 v[30:31], v19 offset:1280
    v_mfma_f32_16x16x32_bf16 v[72:75], v[52:55], v[132:135], v[72:75]
    ds_read_b64_tr_b16 v[32:33], v19 offset:32
    ds_read_b64_tr_b16 v[34:35], v19 offset:1312
    v_mfma_f32_16x16x32_bf16 v[76:79], v[56:59], v[132:135], v[76:79]
    ds_read_b64_tr_b16 v[36:37], v19 offset:64
    ds_read_b64_tr_b16 v[38:39], v19 offset:1344
    s_waitcnt lgkmcnt(6)
    v_mfma_f32_16x16x32_bf16 v[80:83], v[60:63], v[132:135], v[80:83]
    ds_read_b64_tr_b16 v[40:41], v19 offset:96
    ds_read_b64_tr_b16 v[42:43], v19 offset:1376
    v_mfma_f32_16x16x32_bf16 v[84:87], v[64:67], v[132:135], v[84:87]
    ds_read_b64_tr_b16 v[44:45], v19 offset:128
    ds_read_b64_tr_b16 v[46:47], v19 offset:1408
    s_barrier
    buffer_load_dwordx4 v[152:155], v2, s[8:11], s48 offen offset:0 sc1
    buffer_load_dwordx4 v[156:159], v2, s[8:11], s48 offen offset:2048 sc1
    buffer_load_dwordx4 v[160:163], v2, s[8:11], s68 offen offset:0 sc1
    buffer_load_dwordx4 v[164:167], v2, s[8:11], s68 offen offset:2048 sc1
    s_waitcnt vmcnt(7)
    s_waitcnt lgkmcnt(4)
    v_mfma_f32_16x16x32_bf16 v[68:71], v[28:31], v[136:139], v[68:71]
    ds_read_b64_tr_b16 v[48:49], v19 offset:5120
    ds_read_b64_tr_b16 v[50:51], v19 offset:6400
    v_mfma_f32_16x16x32_bf16 v[72:75], v[32:35], v[136:139], v[72:75]
    ds_read_b64_tr_b16 v[52:53], v19 offset:5152
    ds_read_b64_tr_b16 v[54:55], v19 offset:6432
    v_mfma_f32_16x16x32_bf16 v[76:79], v[36:39], v[136:139], v[76:79]
    ds_read_b64_tr_b16 v[56:57], v19 offset:5184
    ds_read_b64_tr_b16 v[58:59], v19 offset:6464
    s_waitcnt lgkmcnt(6)
    v_mfma_f32_16x16x32_bf16 v[80:83], v[40:43], v[136:139], v[80:83]
    ds_read_b64_tr_b16 v[60:61], v19 offset:5216
    ds_read_b64_tr_b16 v[62:63], v19 offset:6496
    v_mfma_f32_16x16x32_bf16 v[84:87], v[44:47], v[136:139], v[84:87]
    ds_read_b64_tr_b16 v[64:65], v19 offset:5248
    ds_read_b64_tr_b16 v[66:67], v19 offset:6528
    s_waitcnt vmcnt(6)
    s_waitcnt lgkmcnt(4)
    v_mfma_f32_16x16x32_bf16 v[68:71], v[48:51], v[140:143], v[68:71]
    ds_read_b64_tr_b16 v[28:29], v19 offset:10240
    ds_read_b64_tr_b16 v[30:31], v19 offset:11520
    v_mfma_f32_16x16x32_bf16 v[72:75], v[52:55], v[140:143], v[72:75]
    ds_read_b64_tr_b16 v[32:33], v19 offset:10272
    ds_read_b64_tr_b16 v[34:35], v19 offset:11552
    v_mfma_f32_16x16x32_bf16 v[76:79], v[56:59], v[140:143], v[76:79]
    ds_read_b64_tr_b16 v[36:37], v19 offset:10304
    ds_read_b64_tr_b16 v[38:39], v19 offset:11584
    s_waitcnt lgkmcnt(6)
    v_mfma_f32_16x16x32_bf16 v[80:83], v[60:63], v[140:143], v[80:83]
    ds_read_b64_tr_b16 v[40:41], v19 offset:10336
    ds_read_b64_tr_b16 v[42:43], v19 offset:11616
    v_mfma_f32_16x16x32_bf16 v[84:87], v[64:67], v[140:143], v[84:87]
    ds_read_b64_tr_b16 v[44:45], v19 offset:10368
    ds_read_b64_tr_b16 v[46:47], v19 offset:11648
    s_waitcnt vmcnt(5)
    s_waitcnt lgkmcnt(4)
    v_mfma_f32_16x16x32_bf16 v[68:71], v[28:31], v[144:147], v[68:71]
    ds_read_b64_tr_b16 v[48:49], v19 offset:15360
    ds_read_b64_tr_b16 v[50:51], v19 offset:16640
    v_mfma_f32_16x16x32_bf16 v[72:75], v[32:35], v[144:147], v[72:75]
    ds_read_b64_tr_b16 v[52:53], v19 offset:15392
    ds_read_b64_tr_b16 v[54:55], v19 offset:16672
    v_mfma_f32_16x16x32_bf16 v[76:79], v[36:39], v[144:147], v[76:79]
    ds_read_b64_tr_b16 v[56:57], v19 offset:15424
    ds_read_b64_tr_b16 v[58:59], v19 offset:16704
    s_waitcnt lgkmcnt(6)
    v_mfma_f32_16x16x32_bf16 v[80:83], v[40:43], v[144:147], v[80:83]
    ds_read_b64_tr_b16 v[60:61], v19 offset:15456
    ds_read_b64_tr_b16 v[62:63], v19 offset:16736
    v_mfma_f32_16x16x32_bf16 v[84:87], v[44:47], v[144:147], v[84:87]
    ds_read_b64_tr_b16 v[64:65], v19 offset:15488
    ds_read_b64_tr_b16 v[66:67], v19 offset:16768
    s_waitcnt vmcnt(4)
    s_waitcnt lgkmcnt(4)
    v_mfma_f32_16x16x32_bf16 v[68:71], v[48:51], v[148:151], v[68:71]
    ds_read_b64_tr_b16 v[28:29], v20 offset:0
    ds_read_b64_tr_b16 v[30:31], v20 offset:1280
    v_mfma_f32_16x16x32_bf16 v[72:75], v[52:55], v[148:151], v[72:75]
    ds_read_b64_tr_b16 v[32:33], v20 offset:32
    ds_read_b64_tr_b16 v[34:35], v20 offset:1312
    v_mfma_f32_16x16x32_bf16 v[76:79], v[56:59], v[148:151], v[76:79]
    ds_read_b64_tr_b16 v[36:37], v20 offset:64
    ds_read_b64_tr_b16 v[38:39], v20 offset:1344
    s_waitcnt lgkmcnt(6)
    v_mfma_f32_16x16x32_bf16 v[80:83], v[60:63], v[148:151], v[80:83]
    ds_read_b64_tr_b16 v[40:41], v20 offset:96
    ds_read_b64_tr_b16 v[42:43], v20 offset:1376
    v_mfma_f32_16x16x32_bf16 v[84:87], v[64:67], v[148:151], v[84:87]
    ds_read_b64_tr_b16 v[44:45], v20 offset:128
    ds_read_b64_tr_b16 v[46:47], v20 offset:1408
    s_waitcnt vmcnt(3)
    s_waitcnt lgkmcnt(4)
    v_mfma_f32_16x16x32_bf16 v[68:71], v[28:31], v[152:155], v[68:71]
    ds_read_b64_tr_b16 v[48:49], v20 offset:5120
    ds_read_b64_tr_b16 v[50:51], v20 offset:6400
    v_mfma_f32_16x16x32_bf16 v[72:75], v[32:35], v[152:155], v[72:75]
    ds_read_b64_tr_b16 v[52:53], v20 offset:5152
    ds_read_b64_tr_b16 v[54:55], v20 offset:6432
    v_mfma_f32_16x16x32_bf16 v[76:79], v[36:39], v[152:155], v[76:79]
    ds_read_b64_tr_b16 v[56:57], v20 offset:5184
    ds_read_b64_tr_b16 v[58:59], v20 offset:6464
    s_waitcnt lgkmcnt(6)
    v_mfma_f32_16x16x32_bf16 v[80:83], v[40:43], v[152:155], v[80:83]
    ds_read_b64_tr_b16 v[60:61], v20 offset:5216
    ds_read_b64_tr_b16 v[62:63], v20 offset:6496
    v_mfma_f32_16x16x32_bf16 v[84:87], v[44:47], v[152:155], v[84:87]
    ds_read_b64_tr_b16 v[64:65], v20 offset:5248
    ds_read_b64_tr_b16 v[66:67], v20 offset:6528
    s_waitcnt vmcnt(2)
    s_waitcnt lgkmcnt(4)
    v_mfma_f32_16x16x32_bf16 v[68:71], v[48:51], v[156:159], v[68:71]
    ds_read_b64_tr_b16 v[28:29], v20 offset:10240
    ds_read_b64_tr_b16 v[30:31], v20 offset:11520
    v_mfma_f32_16x16x32_bf16 v[72:75], v[52:55], v[156:159], v[72:75]
    ds_read_b64_tr_b16 v[32:33], v20 offset:10272
    ds_read_b64_tr_b16 v[34:35], v20 offset:11552
    v_mfma_f32_16x16x32_bf16 v[76:79], v[56:59], v[156:159], v[76:79]
    ds_read_b64_tr_b16 v[36:37], v20 offset:10304
    ds_read_b64_tr_b16 v[38:39], v20 offset:11584
    s_waitcnt lgkmcnt(6)
    v_mfma_f32_16x16x32_bf16 v[80:83], v[60:63], v[156:159], v[80:83]
    ds_read_b64_tr_b16 v[40:41], v20 offset:10336
    ds_read_b64_tr_b16 v[42:43], v20 offset:11616
    v_mfma_f32_16x16x32_bf16 v[84:87], v[64:67], v[156:159], v[84:87]
    ds_read_b64_tr_b16 v[44:45], v20 offset:10368
    ds_read_b64_tr_b16 v[46:47], v20 offset:11648
    s_waitcnt vmcnt(1)
    s_waitcnt lgkmcnt(4)
    v_mfma_f32_16x16x32_bf16 v[68:71], v[28:31], v[160:163], v[68:71]
    ds_read_b64_tr_b16 v[48:49], v20 offset:15360
    ds_read_b64_tr_b16 v[50:51], v20 offset:16640
    v_mfma_f32_16x16x32_bf16 v[72:75], v[32:35], v[160:163], v[72:75]
    ds_read_b64_tr_b16 v[52:53], v20 offset:15392
    ds_read_b64_tr_b16 v[54:55], v20 offset:16672
    v_mfma_f32_16x16x32_bf16 v[76:79], v[36:39], v[160:163], v[76:79]
    ds_read_b64_tr_b16 v[56:57], v20 offset:15424
    ds_read_b64_tr_b16 v[58:59], v20 offset:16704
    s_waitcnt lgkmcnt(6)
    v_mfma_f32_16x16x32_bf16 v[80:83], v[40:43], v[160:163], v[80:83]
    ds_read_b64_tr_b16 v[60:61], v20 offset:15456
    ds_read_b64_tr_b16 v[62:63], v20 offset:16736
    v_mfma_f32_16x16x32_bf16 v[84:87], v[44:47], v[160:163], v[84:87]
    ds_read_b64_tr_b16 v[64:65], v20 offset:15488
    ds_read_b64_tr_b16 v[66:67], v20 offset:16768
    s_waitcnt vmcnt(0)
    s_waitcnt lgkmcnt(4)
    v_mfma_f32_16x16x32_bf16 v[68:71], v[48:51], v[164:167], v[68:71]
    v_mfma_f32_16x16x32_bf16 v[72:75], v[52:55], v[164:167], v[72:75]
    v_mfma_f32_16x16x32_bf16 v[76:79], v[56:59], v[164:167], v[76:79]
    s_waitcnt lgkmcnt(0)
    v_mfma_f32_16x16x32_bf16 v[80:83], v[60:63], v[164:167], v[80:83]
    v_mfma_f32_16x16x32_bf16 v[84:87], v[64:67], v[164:167], v[84:87]
    s_nop 7
    v_cvt_pk_bf16_f32 v68, v68, v69
    v_cvt_pk_bf16_f32 v69, v70, v71
    v_cvt_pk_bf16_f32 v70, v72, v73
    v_cvt_pk_bf16_f32 v71, v74, v75
    s_nop 1
    v_permlane16_swap_b32 v68, v70
    v_permlane16_swap_b32 v69, v71
    buffer_store_dwordx4 v[68:71], v4, s[16:19], s40 offen offset:0
    v_cvt_pk_bf16_f32 v76, v76, v77
    v_cvt_pk_bf16_f32 v77, v78, v79
    v_cvt_pk_bf16_f32 v78, v80, v81
    v_cvt_pk_bf16_f32 v79, v82, v83
    s_nop 1
    v_permlane16_swap_b32 v76, v78
    v_permlane16_swap_b32 v77, v79
    buffer_store_dwordx4 v[76:79], v4, s[16:19], s40 offen offset:64
    v_cvt_pk_bf16_f32 v84, v84, v85
    v_cvt_pk_bf16_f32 v85, v86, v87
    buffer_store_dwordx2 v[84:85], v5, s[16:19], s40 offen offset:128
L_fin:
L_end:
    s_endpgm
L_p2_slow:
    v_mov_b32 v152, 0xff800000
    v_mov_b32 v153, 0xff800000
    v_mov_b32 v246, v242
    v_mov_b32 v247, v243
    v_mov_b32 v253, v248
    s_mov_b32 s21, 0
    s_movk_i32 s40, 0x1000
L_p2_slow0:
    buffer_load_dwordx4 v[32:35], v246, s[8:11], 0 offen offset:0 sc1
    buffer_load_dwordx4 v[36:39], v246, s[8:11], 0 offen offset:1024 sc1
    buffer_load_dwordx4 v[40:43], v246, s[8:11], 0 offen offset:2048 sc1
    buffer_load_dwordx4 v[44:47], v246, s[8:11], 0 offen offset:3072 sc1
    buffer_load_dwordx4 v[48:51], v253, s[8:11], s40 offen offset:0 sc1
    buffer_load_dwordx4 v[52:55], v253, s[8:11], s40 offen offset:512 sc1
    s_waitcnt vmcnt(0)
    v_mfma_f32_32x32x4_2b_bf16 v[56:87], v[48:49], v[24:25], 0
    s_nop 15
    s_nop 3
    v_mfma_f32_32x32x16_bf16 v[56:71], v[32:35], v[16:19], v[56:71]
    v_mfma_f32_32x32x16_bf16 v[72:87], v[32:35], v[20:23], v[72:87]
    s_nop 15
    v_max3_f32 v152, v152, v56, v57
    v_max3_f32 v152, v152, v58, v59
    v_max3_f32 v152, v152, v60, v61
    v_max3_f32 v152, v152, v62, v63
    v_max3_f32 v152, v152, v64, v65
    v_max3_f32 v152, v152, v66, v67
    v_max3_f32 v152, v152, v68, v69
    v_max3_f32 v152, v152, v70, v71
    v_max3_f32 v153, v153, v72, v73
    v_max3_f32 v153, v153, v74, v75
    v_max3_f32 v153, v153, v76, v77
    v_max3_f32 v153, v153, v78, v79
    v_max3_f32 v153, v153, v80, v81
    v_max3_f32 v153, v153, v82, v83
    v_max3_f32 v153, v153, v84, v85
    v_max3_f32 v153, v153, v86, v87
    v_mfma_f32_32x32x4_2b_bf16 v[56:87], v[50:51], v[24:25], 0
    s_nop 15
    s_nop 3
    v_mfma_f32_32x32x16_bf16 v[56:71], v[36:39], v[16:19], v[56:71]
    v_mfma_f32_32x32x16_bf16 v[72:87], v[36:39], v[20:23], v[72:87]
    s_nop 15
    v_max3_f32 v152, v152, v56, v57
    v_max3_f32 v152, v152, v58, v59
    v_max3_f32 v152, v152, v60, v61
    v_max3_f32 v152, v152, v62, v63
    v_max3_f32 v152, v152, v64, v65
    v_max3_f32 v152, v152, v66, v67
    v_max3_f32 v152, v152, v68, v69
    v_max3_f32 v152, v152, v70, v71
    v_max3_f32 v153, v153, v72, v73
    v_max3_f32 v153, v153, v74, v75
    v_max3_f32 v153, v153, v76, v77
    v_max3_f32 v153, v153, v78, v79
    v_max3_f32 v153, v153, v80, v81
    v_max3_f32 v153, v153, v82, v83
    v_max3_f32 v153, v153, v84, v85
    v_max3_f32 v153, v153, v86, v87
    v_mfma_f32_32x32x4_2b_bf16 v[56:87], v[52:53], v[24:25], 0
    s_nop 15
    s_nop 3
    v_mfma_f32_32x32x16_bf16 v[56:71], v[40:43], v[16:19], v[56:71]
    v_mfma_f32_32x32x16_bf16 v[72:87], v[40:43], v[20:23], v[72:87]
    s_nop 15
    v_max3_f32 v152, v152, v56, v57
    v_max3_f32 v152, v152, v58, v59
    v_max3_f32 v152, v152, v60, v61
    v_max3_f32 v152, v152, v62, v63
    v_max3_f32 v152, v152, v64, v65
    v_max3_f32 v152, v152, v66, v67
    v_max3_f32 v152, v152, v68, v69
    v_max3_f32 v152, v152, v70, v71
    v_max3_f32 v153, v153, v72, v73
    v_max3_f32 v153, v153, v74, v75
    v_max3_f32 v153, v153, v76, v77
    v_max3_f32 v153, v153, v78, v79
    v_max3_f32 v153, v153, v80, v81
    v_max3_f32 v153, v153, v82, v83
    v_max3_f32 v153, v153, v84, v85
    v_max3_f32 v153, v153, v86, v87
    v_mfma_f32_32x32x4_2b_bf16 v[56:87], v[54:55], v[24:25], 0
    s_nop 15
    s_nop 3
    v_mfma_f32_32x32x16_bf16 v[56:71], v[44:47], v[16:19], v[56:71]
    v_mfma_f32_32x32x16_bf16 v[72:87], v[44:47], v[20:23], v[72:87]
    s_nop 15
    v_max3_f32 v152, v152, v56, v57
    v_max3_f32 v152, v152, v58, v59
    v_max3_f32 v152, v152, v60, v61
    v_max3_f32 v152, v152, v62, v63
    v_max3_f32 v152, v152, v64, v65
    v_max3_f32 v152, v152, v66, v67
    v_max3_f32 v152, v152, v68, v69
    v_max3_f32 v152, v152, v70, v71
    v_max3_f32 v153, v153, v72, v73
    v_max3_f32 v153, v153, v74, v75
    v_max3_f32 v153, v153, v76, v77
    v_max3_f32 v153, v153, v78, v79
    v_max3_f32 v153, v153, v80, v81
    v_max3_f32 v153, v153, v82, v83
    v_max3_f32 v153, v153, v84, v85
    v_max3_f32 v153, v153, v86, v87
    v_add_u32 v246, 10240, v246
    v_add_u32 v247, 10240, v247
    v_add_u32 v253, 10240, v253
    s_add_u32 s21, s21, 1
    s_cmp_lg_u32 s21, 16
    s_cbranch_scc1 L_p2_slow0
    v_mov_b32 v14, v152
    v_mov_b32 v15, v152
    s_nop 1
    v_permlane32_swap_b32 v14, v15
    s_nop 1
    v_max_f32 v14, v14, v15
    v_sub_f32 v14, 0, v14
    v_mov_b32 v88, v14
    v_mov_b32 v89, v14
    v_mov_b32 v90, v14
    v_mov_b32 v91, v14
    v_mov_b32 v92, v14
    v_mov_b32 v93, v14
    v_mov_b32 v94, v14
    v_mov_b32 v95, v14
    v_mov_b32 v96, v14
    v_mov_b32 v97, v14
    v_mov_b32 v98, v14
    v_mov_b32 v99, v14
    v_mov_b32 v100, v14
    v_mov_b32 v101, v14
    v_mov_b32 v102, v14
    v_mov_b32 v103, v14
    v_mov_b32 v200, 0
    v_mov_b32 v201, 0
    v_mov_b32 v202, 0
    v_mov_b32 v203, 0
    v_mov_b32 v204, 0
    v_mov_b32 v205, 0
    v_mov_b32 v206, 0
    v_mov_b32 v207, 0
    v_mov_b32 v208, 0
    v_mov_b32 v209, 0
    v_mov_b32 v210, 0
    v_mov_b32 v211, 0
    v_mov_b32 v212, 0
    v_mov_b32 v213, 0
    v_mov_b32 v214, 0
    v_mov_b32 v215, 0
    v_mov_b32 v14, v153
    v_mov_b32 v15, v153
    s_nop 1
    v_permlane32_swap_b32 v14, v15
    s_nop 1
    v_max_f32 v14, v14, v15
    v_sub_f32 v14, 0, v14
    v_mov_b32 v104, v14
    v_mov_b32 v105, v14
    v_mov_b32 v106, v14
    v_mov_b32 v107, v14
    v_mov_b32 v108, v14
    v_mov_b32 v109, v14
    v_mov_b32 v110, v14
    v_mov_b32 v111, v14
    v_mov_b32 v112, v14
    v_mov_b32 v113, v14
    v_mov_b32 v114, v14
    v_mov_b32 v115, v14
    v_mov_b32 v116, v14
    v_mov_b32 v117, v14
    v_mov_b32 v118, v14
    v_mov_b32 v119, v14
    v_mov_b32 v216, 0
    v_mov_b32 v217, 0
    v_mov_b32 v218, 0
    v_mov_b32 v219, 0
    v_mov_b32 v220, 0
    v_mov_b32 v221, 0
    v_mov_b32 v222, 0
    v_mov_b32 v223, 0
    v_mov_b32 v224, 0
    v_mov_b32 v225, 0
    v_mov_b32 v226, 0
    v_mov_b32 v227, 0
    v_mov_b32 v228, 0
    v_mov_b32 v229, 0
    v_mov_b32 v230, 0
    v_mov_b32 v231, 0
    v_mov_b32 v246, v242
    v_mov_b32 v247, v243
    v_mov_b32 v253, v248
    s_mov_b32 s21, 0
    s_movk_i32 s40, 0x1000
L_p2_slow1:
    buffer_load_dwordx4 v[32:35], v246, s[8:11], 0 offen offset:0 sc1
    buffer_load_dwordx4 v[36:39], v246, s[8:11], 0 offen offset:1024 sc1
    buffer_load_dwordx4 v[40:43], v246, s[8:11], 0 offen offset:2048 sc1
    buffer_load_dwordx4 v[44:47], v246, s[8:11], 0 offen offset:3072 sc1
    buffer_load_dwordx4 v[48:51], v253, s[8:11], s40 offen offset:0 sc1
    buffer_load_dwordx4 v[52:55], v253, s[8:11], s40 offen offset:512 sc1
    s_mov_b64 exec, s[22:23]
    buffer_load_dwordx4 v[168:171], v247, s[8:11], 0 offen offset:0 sc1
    buffer_load_dwordx4 v[172:175], v247, s[8:11], 0 offen offset:640 sc1
    buffer_load_dwordx4 v[176:179], v247, s[8:11], 0 offen offset:1280 sc1
    buffer_load_dwordx4 v[180:183], v247, s[8:11], 0 offen offset:1920 sc1
    buffer_load_dwordx4 v[184:187], v247, s[8:11], 0 offen offset:2560 sc1
    buffer_load_dwordx4 v[188:191], v247, s[8:11], 0 offen offset:3200 sc1
    buffer_load_dwordx4 v[192:195], v247, s[8:11], 0 offen offset:3840 sc1
    buffer_load_dwordx4 v[196:199], v247, s[8:11], s40 offen offset:384 sc1
    s_mov_b64 exec, -1
    s_waitcnt vmcnt(0)
    v_mfma_f32_32x32x4_2b_bf16 v[56:87], v[48:49], v[24:25], v[88:119]
    s_nop 15
    s_nop 3
    v_mfma_f32_32x32x16_bf16 v[56:71], v[32:35], v[16:19], v[56:71]
    v_mfma_f32_32x32x16_bf16 v[72:87], v[32:35], v[20:23], v[72:87]
    s_nop 15
    v_exp_f32 v56, v56
    v_exp_f32 v57, v57
    v_exp_f32 v58, v58
    v_exp_f32 v59, v59
    v_exp_f32 v60, v60
    v_exp_f32 v61, v61
    v_exp_f32 v62, v62
    v_exp_f32 v63, v63
    v_exp_f32 v64, v64
    v_exp_f32 v65, v65
    v_exp_f32 v66, v66
    v_exp_f32 v67, v67
    v_exp_f32 v68, v68
    v_exp_f32 v69, v69
    v_exp_f32 v70, v70
    v_exp_f32 v71, v71
    s_nop 1
    v_smfmac_f32_32x32x32_bf16 v[200:215], v[168:171], v[56:63], v244
    v_smfmac_f32_32x32x32_bf16 v[200:215], v[172:175], v[64:71], v244
    v_exp_f32 v72, v72
    v_exp_f32 v73, v73
    v_exp_f32 v74, v74
    v_exp_f32 v75, v75
    v_exp_f32 v76, v76
    v_exp_f32 v77, v77
    v_exp_f32 v78, v78
    v_exp_f32 v79, v79
    v_exp_f32 v80, v80
    v_exp_f32 v81, v81
    v_exp_f32 v82, v82
    v_exp_f32 v83, v83
    v_exp_f32 v84, v84
    v_exp_f32 v85, v85
    v_exp_f32 v86, v86
    v_exp_f32 v87, v87
    s_nop 1
    v_smfmac_f32_32x32x32_bf16 v[216:231], v[168:171], v[72:79], v244
    v_smfmac_f32_32x32x32_bf16 v[216:231], v[172:175], v[80:87], v244
    v_mfma_f32_32x32x4_2b_bf16 v[56:87], v[50:51], v[24:25], v[88:119]
    s_nop 15
    s_nop 3
    v_mfma_f32_32x32x16_bf16 v[56:71], v[36:39], v[16:19], v[56:71]
    v_mfma_f32_32x32x16_bf16 v[72:87], v[36:39], v[20:23], v[72:87]
    s_nop 15
    v_exp_f32 v56, v56
    v_exp_f32 v57, v57
    v_exp_f32 v58, v58
    v_exp_f32 v59, v59
    v_exp_f32 v60, v60
    v_exp_f32 v61, v61
    v_exp_f32 v62, v62
    v_exp_f32 v63, v63
    v_exp_f32 v64, v64
    v_exp_f32 v65, v65
    v_exp_f32 v66, v66
    v_exp_f32 v67, v67
    v_exp_f32 v68, v68
    v_exp_f32 v69, v69
    v_exp_f32 v70, v70
    v_exp_f32 v71, v71
    s_nop 1
    v_smfmac_f32_32x32x32_bf16 v[200:215], v[176:179], v[56:63], v244
    v_smfmac_f32_32x32x32_bf16 v[200:215], v[180:183], v[64:71], v244
    v_exp_f32 v72, v72
    v_exp_f32 v73, v73
    v_exp_f32 v74, v74
    v_exp_f32 v75, v75
    v_exp_f32 v76, v76
    v_exp_f32 v77, v77
    v_exp_f32 v78, v78
    v_exp_f32 v79, v79
    v_exp_f32 v80, v80
    v_exp_f32 v81, v81
    v_exp_f32 v82, v82
    v_exp_f32 v83, v83
    v_exp_f32 v84, v84
    v_exp_f32 v85, v85
    v_exp_f32 v86, v86
    v_exp_f32 v87, v87
    s_nop 1
    v_smfmac_f32_32x32x32_bf16 v[216:231], v[176:179], v[72:79], v244
    v_smfmac_f32_32x32x32_bf16 v[216:231], v[180:183], v[80:87], v244
    v_mfma_f32_32x32x4_2b_bf16 v[56:87], v[52:53], v[24:25], v[88:119]
    s_nop 15
    s_nop 3
    v_mfma_f32_32x32x16_bf16 v[56:71], v[40:43], v[16:19], v[56:71]
    v_mfma_f32_32x32x16_bf16 v[72:87], v[40:43], v[20:23], v[72:87]
    s_nop 15
    v_exp_f32 v56, v56
    v_exp_f32 v57, v57
    v_exp_f32 v58, v58
    v_exp_f32 v59, v59
    v_exp_f32 v60, v60
    v_exp_f32 v61, v61
    v_exp_f32 v62, v62
    v_exp_f32 v63, v63
    v_exp_f32 v64, v64
    v_exp_f32 v65, v65
    v_exp_f32 v66, v66
    v_exp_f32 v67, v67
    v_exp_f32 v68, v68
    v_exp_f32 v69, v69
    v_exp_f32 v70, v70
    v_exp_f32 v71, v71
    s_nop 1
    v_smfmac_f32_32x32x32_bf16 v[200:215], v[184:187], v[56:63], v244
    v_smfmac_f32_32x32x32_bf16 v[200:215], v[188:191], v[64:71], v244
    v_exp_f32 v72, v72
    v_exp_f32 v73, v73
    v_exp_f32 v74, v74
    v_exp_f32 v75, v75
    v_exp_f32 v76, v76
    v_exp_f32 v77, v77
    v_exp_f32 v78, v78
    v_exp_f32 v79, v79
    v_exp_f32 v80, v80
    v_exp_f32 v81, v81
    v_exp_f32 v82, v82
    v_exp_f32 v83, v83
    v_exp_f32 v84, v84
    v_exp_f32 v85, v85
    v_exp_f32 v86, v86
    v_exp_f32 v87, v87
    s_nop 1
    v_smfmac_f32_32x32x32_bf16 v[216:231], v[184:187], v[72:79], v244
    v_smfmac_f32_32x32x32_bf16 v[216:231], v[188:191], v[80:87], v244
    v_mfma_f32_32x32x4_2b_bf16 v[56:87], v[54:55], v[24:25], v[88:119]
    s_nop 15
    s_nop 3
    v_mfma_f32_32x32x16_bf16 v[56:71], v[44:47], v[16:19], v[56:71]
    v_mfma_f32_32x32x16_bf16 v[72:87], v[44:47], v[20:23], v[72:87]
    s_nop 15
    v_exp_f32 v56, v56
    v_exp_f32 v57, v57
    v_exp_f32 v58, v58
    v_exp_f32 v59, v59
    v_exp_f32 v60, v60
    v_exp_f32 v61, v61
    v_exp_f32 v62, v62
    v_exp_f32 v63, v63
    v_exp_f32 v64, v64
    v_exp_f32 v65, v65
    v_exp_f32 v66, v66
    v_exp_f32 v67, v67
    v_exp_f32 v68, v68
    v_exp_f32 v69, v69
    v_exp_f32 v70, v70
    v_exp_f32 v71, v71
    s_nop 1
    v_smfmac_f32_32x32x32_bf16 v[200:215], v[192:195], v[56:63], v244
    v_smfmac_f32_32x32x32_bf16 v[200:215], v[196:199], v[64:71], v244
    v_exp_f32 v72, v72
    v_exp_f32 v73, v73
    v_exp_f32 v74, v74
    v_exp_f32 v75, v75
    v_exp_f32 v76, v76
    v_exp_f32 v77, v77
    v_exp_f32 v78, v78
    v_exp_f32 v79, v79
    v_exp_f32 v80, v80
    v_exp_f32 v81, v81
    v_exp_f32 v82, v82
    v_exp_f32 v83, v83
    v_exp_f32 v84, v84
    v_exp_f32 v85, v85
    v_exp_f32 v86, v86
    v_exp_f32 v87, v87
    s_nop 1
    v_smfmac_f32_32x32x32_bf16 v[216:231], v[192:195], v[72:79], v244
    v_smfmac_f32_32x32x32_bf16 v[216:231], v[196:199], v[80:87], v244
    v_add_u32 v246, 10240, v246
    v_add_u32 v247, 10240, v247
    v_add_u32 v253, 10240, v253
    s_add_u32 s21, s21, 1
    s_cmp_lg_u32 s21, 16
    s_cbranch_scc1 L_p2_slow1
    s_nop 15
    s_branch L_p2_fin
.p2align 5
L_tab:
.byte 12, 2, 5, 15, 13, 3, 6, 4, 7, 9, 10, 0, 14, 8, 11, 1, 66, 2, 64, 0, 1, 1, 35, 0, 33, 2, 65, 1, 2, 2, 0, 0
.byte 17, 22, 20, 19, 16, 23, 21, 18, 30, 24, 25, 27, 31, 29, 26, 28, 3, 3, 68, 4, 4, 4, 67, 3, 6, 6, 36, 5, 5, 5, 69, 5
.byte 5, 3, 0, 2, 6, 4, 1, 7, 10, 15, 8, 13, 11, 12, 9, 14, 71, 7, 7, 7, 70, 6, 38, 7, 64, 0, 33, 0, 0, 0, 1, 1
.byte 20, 27, 18, 25, 21, 26, 19, 24, 17, 23, 28, 30, 16, 22, 29, 31, 66, 2, 67, 3, 2, 2, 3, 3, 65, 1, 35, 2, 4, 4, 68, 4
.byte 0, 10, 11, 13, 5, 15, 12, 14, 6, 1, 3, 8, 7, 2, 4, 9, 36, 5, 38, 7, 7, 7, 71, 7, 6, 6, 5, 5, 69, 5, 70, 6
.byte 16, 17, 18, 19, 20, 21, 22, 23, 24, 25, 26, 27, 28, 29, 30, 31, 0, 0, 0, 0, 0, 0, 0, 0, 0, 0, 0, 0, 0, 0, 0, 0
.byte 0, 1, 2, 3, 4, 5, 6, 7, 8, 9, 10, 11, 12, 13, 14, 15, 0, 0, 0, 0, 0, 0, 0, 0, 0, 0, 0, 0, 0, 0, 0, 0
.byte 16, 17, 18, 19, 20, 21, 22, 23, 24, 25, 26, 27, 28, 29, 30, 31, 0, 0, 0, 0, 0, 0, 0, 0, 0, 0, 0, 0, 0, 0, 0, 0
.long 0, 15424, 18048, 29472, 16, 15440, 18064, 29488, 32, 15456, 19200, 29504, 48, 15472, 19216, 29520
.long 64, 15488, 19232, 29536, 80, 15504, 19248, 29552, 96, 16640, 19264, 29568, 112, 16656, 19280, 29584
.long 128, 16672, 19296, 38400, 144, 16688, 19312, 38416, 1280, 16704, 19328, 38432, 1296, 16720, 19344, 38448
.long 1312, 16736, 20480, 38464, 1328, 16752, 20496, 38480, 1344, 16768, 20512, 38496, 1360, 16784, 20528, 38512
.long 1376, 5120, 20544, 38528, 1392, 5136, 20560, 38544, 1408, 5152, 20576, 39680, 1424, 5168, 20592, 39696
.long 2560, 5184, 20608, 39712, 2576, 5200, 20624, 39728, 2592, 5216, 21760, 39744, 2608, 5232, 21776, 39760
.long 2624, 5248, 21792, 39776, 2640, 5264, 21808, 39792, 2656, 6400, 21824, 39808, 2672, 6416, 21840, 39824
.long 2688, 6432, 21856, 40960, 2704, 6448, 21872, 40976, 3840, 6464, 21888, 40992, 3856, 6480, 21904, 41008
.long 3872, 6496, 25600, 41024, 3888, 6512, 25616, 41040, 3904, 6528, 25632, 41056, 3920, 6544, 25648, 41072
.long 3936, 7680, 25664, 41088, 3952, 7696, 25680, 41104, 3968, 7712, 25696, 42240, 3984, 7728, 25712, 42256
.long 12800, 7744, 25728, 42272, 12816, 7760, 25744, 42288, 12832, 7776, 26880, 42304, 12848, 7792, 26896, 42320
.long 12864, 7808, 26912, 42336, 12880, 7824, 26928, 42352, 12896, 8960, 26944, 42368, 12912, 8976, 26960, 42384
.long 12928, 8992, 26976, 30720, 12944, 9008, 26992, 30736, 14080, 9024, 27008, 30752, 14096, 9040, 27024, 30768
.long 14112, 9056, 28160, 30784, 14128, 9072, 28176, 30800, 14144, 9088, 28192, 30816, 14160, 9104, 28208, 30832
.long 14176, 17920, 28224, 30848, 14192, 17936, 28240, 30864, 14208, 17952, 28256, 32000, 14224, 17968, 28272, 32016
.long 15360, 17984, 28288, 32032, 15376, 18000, 28304, 32048, 15392, 18016, 29440, 32064, 15408, 18032, 29456, 32080
.long 32096, 10240, 74304, 87168, 32112, 10256, 74320, 87184, 32128, 10272, 74336, 88320, 32144, 10288, 74352, 88336
.long 33280, 10304, 74368, 88352, 33296, 10320, 74384, 88368, 33312, 10336, 75520, 88384, 33328, 10352, 75536, 88400
.long 33344, 10368, 75552, 88416, 33360, 10384, 75568, 88432, 33376, 11520, 75584, 88448, 33392, 11536, 75600, 88464
.long 33408, 11552, 75616, 99840, 33424, 11568, 75632, 99856, 34560, 11584, 75648, 99872, 34576, 11600, 75664, 99888
.long 34592, 11616, 35840, 99904, 34608, 11632, 35856, 99920, 34624, 11648, 35872, 99936, 34640, 11664, 35888, 99952
.long 34656, 23040, 35904, 99968, 34672, 23056, 35920, 99984, 34688, 23072, 35936, 101120, 34704, 23088, 35952, 101136
.long 43520, 23104, 35968, 101152, 43536, 23120, 35984, 101168, 43552, 23136, 37120, 101184, 43568, 23152, 37136, 101200
.long 43584, 23168, 37152, 101216, 43600, 23184, 37168, 101232, 43616, 24320, 37184, 101248, 43632, 24336, 37200, 101264
.long 43648, 24352, 37216, 112640, 43664, 24368, 37232, 112656, 44800, 24384, 37248, 112672, 44816, 24400, 37264, 112688
.long 44832, 24416, 48640, 112704, 44848, 24432, 48656, 112720, 44864, 24448, 48672, 112736, 44880, 24464, 48688, 112752
.long 44896, 61440, 48704, 112768, 44912, 61456, 48720, 112784, 44928, 61472, 48736, 113920, 44944, 61488, 48752, 113936
.long 46080, 61504, 48768, 113952, 46096, 61520, 48784, 113968, 46112, 61536, 49920, 113984, 46128, 61552, 49936, 114000
.long 46144, 61568, 49952, 114016, 46160, 61584, 49968, 114032, 46176, 62720, 49984, 114048, 46192, 62736, 50000, 114064
.long 46208, 62752, 50016, 125440, 46224, 62768, 50032, 125456, 47360, 62784, 50048, 125472, 47376, 62800, 50064, 125488
.long 47392, 62816, 87040, 125504, 47408, 62832, 87056, 125520, 47424, 62848, 87072, 125536, 47440, 62864, 87088, 125552
.long 47456, 74240, 87104, 125568, 47472, 74256, 87120, 125584, 47488, 74272, 87136, 126720, 47504, 74288, 87152, 126736
.long 126752, 139616, 126768, 139632, 126784, 139648, 126800, 139664
.long 126816, 151040, 126832, 151056, 126848, 151072, 126864, 151088
.long 163840, 151104, 163856, 151120, 163872, 151136, 163888, 151152
.long 163904, 151168, 163920, 151184, 163936, 152320, 163952, 152336
.long 163968, 152352, 163984, 152368, 165120, 152384, 165136, 152400
.long 165152, 152416, 165168, 152432, 165184, 152448, 165200, 152464
.long 165216, 189440, 165232, 189456, 165248, 189472, 165264, 189488
.long 176640, 189504, 176656, 189520, 176672, 189536, 176688, 189552
.long 176704, 189568, 176720, 189584, 176736, 190720, 176752, 190736
.long 176768, 190752, 176784, 190768, 177920, 190784, 177936, 190800
.long 177952, 190816, 177968, 190832, 177984, 190848, 178000, 190864
.long 178016, 202240, 178032, 202256, 178048, 202272, 178064, 202288
.long 138240, 202304, 138256, 202320, 138272, 202336, 138288, 202352
.long 138304, 202368, 138320, 202384, 138336, 203520, 138352, 203536
.long 138368, 203552, 138384, 203568, 139520, 203584, 139536, 203600
.long 139552, 203616, 139568, 203632, 139584, 203648, 139600, 203664
.p2align 2
.section .rodata,"a"
.p2align 6
.amdhsa_kernel concat_heads__mha_block__mha_block__prompt_kernel
  .amdhsa_next_free_vgpr 256
  .amdhsa_next_free_sgpr 100
  .amdhsa_accum_offset 256
  .amdhsa_group_segment_fixed_size 0
  .amdhsa_kernarg_size 72
  .amdhsa_user_sgpr_count 2
  .amdhsa_user_sgpr_kernarg_segment_ptr 1
  .amdhsa_system_sgpr_workgroup_id_x 1
.end_amdhsa_kernel
.text
```
